```python
import torch

def _softmax(x, axis=-1):
    return torch.softmax(x, dim=axis)
def _gelu(x):
    return torch.nn.functional.gelu(x, approximate="tanh")
def _silu(x):
    return torch.nn.functional.silu(x)
def _sigmoid(x):
    return torch.sigmoid(x)
def _layernorm(x, axis=-1, eps=1e-5):
    m = x.mean(dim=axis, keepdim=True)
    v = x.var(dim=axis, keepdim=True, unbiased=False)
    return (x - m) / torch.sqrt(v + eps)
def _scatter_add(tgt, idx, src, axis=0):
    return tgt.clone().index_add_(axis, idx, src)
def _segment_sum(src, seg, n):
    out = torch.zeros((n,) + src.shape[1:], dtype=src.dtype)
    return out.index_add_(0, seg, src)
def _pad(x, pw):
    flat = tuple(v for pair in reversed(pw) for v in pair)
    return torch.nn.functional.pad(x, flat)

kernel_name = 'concat_heads__gqa_block_cached__mha_block_cached__near_ridge'

def setup_inputs():

    _w = (lambda a: (lambda t: t.to(torch.bfloat16) if t.is_floating_point() else t)(torch.as_tensor(a)))
    def _A_setup():
        B, Sq, D = 8, 80, 512
        Hq, Hkv, Sk, Dh = 32, 8, 2048, 128
        assert Hq % Hkv == 0, (Hq, Hkv)
        return {
            "x": _w((lambda *s: torch.randn(*s, dtype=torch.bfloat16) * 0.8)(B, Sq, D)),
            "k_cache": _w((lambda *s: torch.randn(*s, dtype=torch.bfloat16) * 0.8)(B, Hkv, Sk, Dh)),
            "v_cache": _w((lambda *s: torch.randn(*s, dtype=torch.bfloat16) * 0.05)(B, Hkv, Sk, Dh)),
            "wq": _w((lambda *s: torch.randn(*s, dtype=torch.bfloat16) * 0.8)(D, Hq * Dh) * (D ** -0.5)),
            "wo": _w((lambda *s: torch.randn(*s, dtype=torch.bfloat16) * 0.05)(Hq * Dh, D) * ((Hq * Dh) ** -0.5)),
        }
    _A_in = _A_setup()

    def _B_setup():
        B, Sq, D = 8, 80, 512
        H, Sk, Dh = 32, 2048, 128
        return {
            "x": _w((lambda *s: torch.randn(*s, dtype=torch.bfloat16) * 0.8)(B, Sq, D)),
            "k_cache": _w((lambda *s: torch.randn(*s, dtype=torch.bfloat16) * 0.8)(B, H, Sk, Dh)),
            "v_cache": _w((lambda *s: torch.randn(*s, dtype=torch.bfloat16) * 0.05)(B, H, Sk, Dh)),
            "wq": _w((lambda *s: torch.randn(*s, dtype=torch.bfloat16) * 0.8)(D, H * Dh) * (D ** -0.5)),
            "wo": _w((lambda *s: torch.randn(*s, dtype=torch.bfloat16) * 0.05)(H * Dh, D) * ((H * Dh) ** -0.5)),
        }
    _B_in = _B_setup()

    return {
        "A_x": _A_in["x"],
        "A_k_cache": _A_in["k_cache"],
        "A_v_cache": _A_in["v_cache"],
        "A_wq": _A_in["wq"],
        "A_wo": _A_in["wo"],
        "B_x": _B_in["x"],
        "B_k_cache": _B_in["k_cache"],
        "B_v_cache": _B_in["v_cache"],
        "B_wq": _B_in["wq"],
        "B_wo": _B_in["wo"],
    }

def reference(A_x, A_k_cache, A_v_cache, A_wq, A_wo, B_x, B_k_cache, B_v_cache, B_wq, B_wo):
    def _A_ref(x, k_cache, v_cache, wq, wo):
        B, Sq, D = x.shape
        Hq, Dh = 32, 128
        Hkv = k_cache.shape[1]
        rep = Hq // Hkv
        q = (lambda x, *d: x.permute(*d))((x @ wq).reshape(B, Sq, Hq, Dh), 0, 2, 1, 3)
        k = (lambda x, n, axis: torch.repeat_interleave(x, n, dim=axis))(k_cache, rep, axis=1)
        v = (lambda x, n, axis: torch.repeat_interleave(x, n, dim=axis))(v_cache, rep, axis=1)
        scores = torch.einsum("bhqd,bhkd->bhqk", q, k) * (Dh ** -0.5)
        p = _softmax(scores, axis=-1)
        o = torch.einsum("bhqk,bhkd->bhqd", p, v)
        return (lambda x, *d: x.permute(*d))(o, 0, 2, 1, 3).reshape(B, Sq, Hq * Dh) @ wo

    def _B_ref(x, k_cache, v_cache, wq, wo):
        B, Sq, D = x.shape
        H, Dh = 32, 128
        q = (lambda x, *d: x.permute(*d))((x @ wq).reshape(B, Sq, H, Dh), 0, 2, 1, 3)
        scores = torch.einsum("bhqd,bhkd->bhqk", q, k_cache) * (Dh ** -0.5)
        p = _softmax(scores, axis=-1)
        o = torch.einsum("bhqk,bhkd->bhqd", p, v_cache)
        return (lambda x, *d: x.permute(*d))(o, 0, 2, 1, 3).reshape(B, Sq, H * Dh) @ wo

    a = _A_ref(A_x, A_k_cache, A_v_cache, A_wq, A_wo)
    b = _B_ref(B_x, B_k_cache, B_v_cache, B_wq, B_wo)
    return torch.concatenate([a, b], axis=-1)
```

```asm
; @launch grid=(256,1,1) block=(256,1,1) lds=163840
.amdgcn_target "amdgcn-amd-amdhsa--gfx950"
.text
.globl concat_heads__gqa_block_cached__mha_block_cached__near_ridge_kernel
.p2align 8
.type concat_heads__gqa_block_cached__mha_block_cached__near_ridge_kernel,@function
concat_heads__gqa_block_cached__mha_block_cached__near_ridge_kernel:
  s_cmp_ge_u32 s2, 256
  s_cbranch_scc1 concat_heads__gqa_block_cached__mha_block_cached__near_ridge_kernel_end
  s_load_dwordx8 s[8:15], s[0:1], 0
  s_load_dwordx8 s[16:23], s[0:1], 40
  s_load_dwordx2 s[24:25], s[0:1], 96
  s_load_dwordx2 s[4:5], s[0:1], 32
  s_load_dwordx2 s[6:7], s[0:1], 72
  v_lshrrev_b32 v3, 6, v0
  v_and_b32 v1, 63, v0
  v_readfirstlane_b32 s26, v3
  v_lshlrev_b32 v2, 4, v1
  s_and_b32 s27, s26, 1
  s_lshr_b32 s31, s26, 1
  s_and_b32 s59, s2, 7
  s_lshr_b32 s60, s2, 3
  s_lshr_b32 s28, s60, 4
  s_and_b32 s75, s60, 15
  s_lshr_b32 s29, s75, 1
  s_and_b32 s60, s75, 1
  s_mul_i32 s61, s28, 1
  s_xor_b32 s59, s59, s61
  s_lshl_b32 s30, s59, 2
  s_lshl_b32 s60, s60, 1
  s_add_u32 s30, s30, s60
  s_add_u32 s30, s30, s31
  s_mul_i32 s52, s26, 40960
  s_xor_b32 s61, s26, 1
  s_mul_i32 s71, s61, 40960
  s_mul_i32 s61, s27, 40960
  s_lshl_b32 s62, s31, 12
  s_cmp_eq_u32 s28, 0
  s_cselect_b32 s64, s61, s52
  s_cselect_b32 s62, s62, 0
  s_add_u32 s65, s64, s62
  s_lshr_b32 s70, s2, 4
  s_mul_i32 s70, s70, 0
  s_and_b32 s70, s70, 31
  s_mul_i32 s70, s70, 16384
  s_mov_b32 s66, 0x3e0293ee
  s_mov_b32 s67, 0x3e0293ee
  s_mov_b32 s68, 16384
  s_mov_b32 s69, 0xffffe000
  s_waitcnt lgkmcnt(0)
  s_cmp_eq_u32 s28, 0
  s_cselect_b32 s8, s8, s16
  s_cselect_b32 s9, s9, s17
  s_cselect_b32 s10, s10, s18
  s_cselect_b32 s11, s11, s19
  s_cselect_b32 s12, s12, s20
  s_cselect_b32 s13, s13, s21
  s_cselect_b32 s14, s14, s22
  s_cselect_b32 s15, s15, s23
  s_cselect_b32 s4, s4, s6
  s_cselect_b32 s5, s5, s7
  s_mov_b32 s16, 0
  s_lshr_b32 s59, s30, 2
  s_lshl_b32 s60, s29, 3
  s_add_u32 s59, s59, s60
  s_lshl_b32 s60, s29, 5
  s_add_u32 s60, s60, s30
  s_cmp_eq_u32 s28, 0
  s_cselect_b32 s59, s59, s60
  s_lshl_b32 s59, s59, 19
  s_lshl_b32 s60, s27, 13
  s_sub_u32 s17, 0x80000, s60
  s_add_u32 s60, s60, s59
  s_add_u32 s32, s10, s60
  s_addc_u32 s33, s11, 0
  s_mov_b32 s34, s17
  s_mov_b32 s35, 0x20000
  s_add_u32 s36, s12, s60
  s_addc_u32 s37, s13, 0
  s_mov_b32 s38, s17
  s_mov_b32 s39, 0x20000
  s_lshl_b32 s59, s30, 8
  s_lshl_b32 s60, s27, 7
  s_add_u32 s59, s59, s60
  s_add_u32 s40, s14, s59
  s_addc_u32 s41, s15, 0
  s_sub_u32 s42, 0x400000, s59
  s_mov_b32 s43, 0x20000
  s_mul_i32 s59, s29, 81920
  s_add_u32 s44, s8, s59
  s_addc_u32 s45, s9, 0
  s_mov_b32 s46, 81920
  s_mov_b32 s47, 0x20000
  s_sub_u32 s59, s30, s31
  s_lshl_b32 s59, s59, 17
  s_lshl_b32 s60, s26, 8
  s_add_u32 s59, s59, s60
  s_add_u32 s80, s4, s59
  s_addc_u32 s81, s5, 0
  s_sub_u32 s82, 0x400000, s59
  s_mov_b32 s83, 0x20000
  s_lshl_b32 s59, s28, 3
  s_add_u32 s59, s59, s29
  s_lshl_b32 s59, s59, 4
  s_lshr_b32 s60, s30, 1
  s_add_u32 s59, s59, s60
  s_mul_i32 s59, s59, 81920
  s_mul_i32 s60, s26, 20480
  s_add_u32 s59, s59, s60
  s_add_u32 s48, s24, s59
  s_addc_u32 s49, s25, 0
  s_mov_b32 s50, 20480
  s_mov_b32 s51, 0x20000
  s_mul_i32 s72, s26, 20
  s_and_b32 s73, s75, 1
  s_mul_i32 s73, s73, 10
  s_add_u32 s59, s72, s73
  s_lshl_b32 s61, s59, 4
  s_lshl_b32 s59, s59, 10
  s_lshl_b32 s60, s73, 10
  s_add_u32 s60, s60, s52
  s_add_u32 m0, s60, 16384
  s_and_b32 s62, s61, 0xf0
  v_xor_b32 v26, s62, v2
  s_add_u32 s61, s61, 16
  buffer_load_dwordx4 v26, s[44:47], s59 offen  lds
  s_and_b32 s62, s61, 0xf0
  v_xor_b32 v27, s62, v2
  s_add_u32 s61, s61, 16
  buffer_load_dwordx4 v27, s[44:47], s59 offen offset:1024  lds
  s_and_b32 s62, s61, 0xf0
  v_xor_b32 v26, s62, v2
  s_add_u32 s61, s61, 16
  buffer_load_dwordx4 v26, s[44:47], s59 offen offset:2048  lds
  s_and_b32 s62, s61, 0xf0
  v_xor_b32 v27, s62, v2
  s_add_u32 s61, s61, 16
  buffer_load_dwordx4 v27, s[44:47], s59 offen offset:3072  lds
  s_add_u32 m0, m0, 4096
  s_add_u32 s59, s59, 4096
  s_and_b32 s62, s61, 0xf0
  v_xor_b32 v26, s62, v2
  s_add_u32 s61, s61, 16
  buffer_load_dwordx4 v26, s[44:47], s59 offen  lds
  s_and_b32 s62, s61, 0xf0
  v_xor_b32 v27, s62, v2
  s_add_u32 s61, s61, 16
  buffer_load_dwordx4 v27, s[44:47], s59 offen offset:1024  lds
  s_and_b32 s62, s61, 0xf0
  v_xor_b32 v26, s62, v2
  s_add_u32 s61, s61, 16
  buffer_load_dwordx4 v26, s[44:47], s59 offen offset:2048  lds
  s_and_b32 s62, s61, 0xf0
  v_xor_b32 v27, s62, v2
  s_add_u32 s61, s61, 16
  buffer_load_dwordx4 v27, s[44:47], s59 offen offset:3072  lds
  s_add_u32 m0, m0, 4096
  s_add_u32 s59, s59, 4096
  s_and_b32 s62, s61, 0xf0
  v_xor_b32 v26, s62, v2
  s_add_u32 s61, s61, 16
  buffer_load_dwordx4 v26, s[44:47], s59 offen  lds
  s_and_b32 s62, s61, 0xf0
  v_xor_b32 v27, s62, v2
  s_add_u32 s61, s61, 16
  buffer_load_dwordx4 v27, s[44:47], s59 offen offset:1024  lds
  s_cmp_lg_u32 s28, 0
  s_cbranch_scc1 concat_heads__gqa_block_cached__mha_block_cached__near_ridge_kernel_nowo
  s_lshr_b32 s59, s30, 2
  s_lshl_b32 s62, s59, 19
  s_add_u32 s76, s4, s62
  s_addc_u32 s77, s5, 0
  s_sub_u32 s78, 0x400000, s62
  s_mov_b32 s79, 0x20000
  s_lshl_b32 s60, s75, 2
  s_add_u32 s60, s60, s26
  s_lshl_b32 s61, s60, 13
  v_lshlrev_b32 v28, 7, v1
  buffer_load_dword v248, v28, s[76:79], s61 offen
  s_xor_b32 s62, s59, 1
  s_lshl_b32 s62, s62, 19
  s_add_u32 s76, s6, s62
  s_addc_u32 s77, s7, 0
  s_sub_u32 s78, 0x400000, s62
  s_nop 0
  buffer_load_dword v249, v28, s[76:79], s61 offen
concat_heads__gqa_block_cached__mha_block_cached__near_ridge_kernel_nowo:
  v_lshrrev_b32 v22, 4, v1
  v_and_b32 v23, 15, v1
  v_lshlrev_b32 v24, 8, v22
  v_lshlrev_b32 v25, 2, v22
  v_xor_b32 v25, v25, v23
  v_xor_b32 v30, 0, v25
  v_lshlrev_b32 v30, 4, v30
  v_add_u32 v16, v24, v30
  v_xor_b32 v30, 1, v25
  v_lshlrev_b32 v30, 4, v30
  v_add_u32 v17, v24, v30
  v_xor_b32 v30, 2, v25
  v_lshlrev_b32 v30, 4, v30
  v_add_u32 v18, v24, v30
  v_xor_b32 v30, 3, v25
  v_lshlrev_b32 v30, 4, v30
  v_add_u32 v19, v24, v30
  v_lshlrev_b32 v30, 1, v22
  v_add_u32 v30, 0, v30
  v_xor_b32 v30, v30, v23
  v_lshlrev_b32 v30, 4, v30
  v_add_u32 v20, v24, v30
  v_lshlrev_b32 v30, 1, v22
  v_add_u32 v30, 8, v30
  v_xor_b32 v30, v30, v23
  v_lshlrev_b32 v30, 4, v30
  v_add_u32 v21, v24, v30
  v_and_b32 v30, 3, v23
  v_lshlrev_b32 v30, 2, v30
  v_lshrrev_b32 v31, 2, v23
  v_or_b32 v30, v30, v31
  v_lshlrev_b32 v31, 2, v22
  v_xor_b32 v30, v30, v31
  v_lshlrev_b32 v28, 8, v23
  v_add_u32 v28, s64, v28
  v_xor_b32 v31, 0, v30
  v_lshlrev_b32 v31, 4, v31
  v_add_u32 v4, v28, v31
  v_xor_b32 v31, 1, v30
  v_lshlrev_b32 v31, 4, v31
  v_add_u32 v5, v28, v31
  v_xor_b32 v31, 2, v30
  v_lshlrev_b32 v31, 4, v31
  v_add_u32 v6, v28, v31
  v_xor_b32 v31, 3, v30
  v_lshlrev_b32 v31, 4, v31
  v_add_u32 v7, v28, v31
  v_lshrrev_b32 v30, 2, v23
  v_lshlrev_b32 v31, 2, v22
  v_add_u32 v30, v30, v31
  v_and_b32 v31, 7, v30
  v_lshlrev_b32 v31, 1, v31
  v_bfe_u32 v28, v23, 1, 1
  v_xor_b32 v31, v31, v28
  s_lshl_b32 s59, s27, 3
  v_xor_b32 v31, s59, v31
  v_lshlrev_b32 v30, 8, v30
  v_and_b32 v28, 1, v23
  v_lshlrev_b32 v28, 3, v28
  v_add_u32 v30, v30, v28
  s_add_u32 s60, s64, 8192
  v_add_u32 v30, s60, v30
  v_xor_b32 v28, 0, v31
  v_lshlrev_b32 v28, 4, v28
  v_add_u32 v8, v30, v28
  v_xor_b32 v28, 2, v31
  v_lshlrev_b32 v28, 4, v28
  v_add_u32 v9, v30, v28
  v_xor_b32 v28, 4, v31
  v_lshlrev_b32 v28, 4, v28
  v_add_u32 v10, v30, v28
  v_xor_b32 v28, 6, v31
  v_lshlrev_b32 v28, 4, v28
  v_add_u32 v11, v30, v28
  v_xor_b32 v28, 8, v31
  v_lshlrev_b32 v28, 4, v28
  v_add_u32 v12, v30, v28
  v_xor_b32 v28, 10, v31
  v_lshlrev_b32 v28, 4, v28
  v_add_u32 v13, v30, v28
  v_xor_b32 v28, 12, v31
  v_lshlrev_b32 v28, 4, v28
  v_add_u32 v14, v30, v28
  v_xor_b32 v28, 14, v31
  v_lshlrev_b32 v28, 4, v28
  v_add_u32 v15, v30, v28
  v_lshrrev_b32 v28, 3, v1
  v_bfe_u32 v29, v28, 1, 1
  v_lshlrev_b32 v29, 1, v29
  v_and_b32 v30, 7, v1
  v_xor_b32 v30, v30, v29
  v_lshlrev_b32 v28, 13, v28
  v_lshlrev_b32 v31, 4, v30
  v_add_u32 v32, v28, v31
  v_xor_b32 v30, 4, v30
  v_lshlrev_b32 v31, 4, v30
  v_add_u32 v33, v28, v31
  v_lshrrev_b32 v28, 2, v23
  v_lshlrev_b32 v29, 3, v22
  v_add_u32 v29, v29, v28
  v_lshlrev_b32 v29, 7, v29
  v_and_b32 v30, 1, v23
  v_lshlrev_b32 v30, 3, v30
  v_add_u32 v29, v29, v30
  v_add_u32 v29, s52, v29
  v_bfe_u32 v30, v28, 1, 1
  v_and_b32 v31, 1, v22
  v_lshlrev_b32 v31, 1, v31
  v_or_b32 v30, v30, v31
  v_lshlrev_b32 v30, 1, v30
  v_bfe_u32 v31, v23, 1, 1
  v_xor_b32 v30, v30, v31
  v_xor_b32 v31, 0, v30
  v_lshlrev_b32 v31, 4, v31
  v_add_u32 v34, v29, v31
  v_xor_b32 v31, 2, v30
  v_lshlrev_b32 v31, 4, v31
  v_add_u32 v35, v29, v31
  v_xor_b32 v31, 4, v30
  v_lshlrev_b32 v31, 4, v31
  v_add_u32 v36, v29, v31
  v_xor_b32 v31, 6, v30
  v_lshlrev_b32 v31, 4, v31
  v_add_u32 v37, v29, v31
  v_add_u32 v28, 0, v23
  v_mul_u32_u24 v29, 0xcccd, v28
  v_lshrrev_b32 v29, 20, v29
  v_mul_u32_u24 v30, 20, v29
  v_sub_u32 v30, v28, v30
  v_mul_u32_u24 v29, 40960, v29
  v_lshlrev_b32 v30, 10, v30
  v_add_u32 v29, v29, v30
  v_xor_b32 v30, v22, v23
  v_lshlrev_b32 v30, 4, v30
  v_add_u32 v29, v29, v30
  v_add_u32 v40, 16384, v29
  v_xor_b32 v41, 64, v40
  v_xor_b32 v42, 128, v40
  v_xor_b32 v43, 192, v40
  v_add_u32 v28, 16, v23
  v_mul_u32_u24 v29, 0xcccd, v28
  v_lshrrev_b32 v29, 20, v29
  v_mul_u32_u24 v30, 20, v29
  v_sub_u32 v30, v28, v30
  v_mul_u32_u24 v29, 40960, v29
  v_lshlrev_b32 v30, 10, v30
  v_add_u32 v29, v29, v30
  v_xor_b32 v30, v22, v23
  v_lshlrev_b32 v30, 4, v30
  v_add_u32 v29, v29, v30
  v_add_u32 v44, 16384, v29
  v_xor_b32 v45, 64, v44
  v_xor_b32 v46, 128, v44
  v_xor_b32 v47, 192, v44
  v_add_u32 v28, 32, v23
  v_mul_u32_u24 v29, 0xcccd, v28
  v_lshrrev_b32 v29, 20, v29
  v_mul_u32_u24 v30, 20, v29
  v_sub_u32 v30, v28, v30
  v_mul_u32_u24 v29, 40960, v29
  v_lshlrev_b32 v30, 10, v30
  v_add_u32 v29, v29, v30
  v_xor_b32 v30, v22, v23
  v_lshlrev_b32 v30, 4, v30
  v_add_u32 v29, v29, v30
  v_add_u32 v48, 16384, v29
  v_xor_b32 v49, 64, v48
  v_xor_b32 v50, 128, v48
  v_xor_b32 v51, 192, v48
  v_add_u32 v28, 48, v23
  v_mul_u32_u24 v29, 0xcccd, v28
  v_lshrrev_b32 v29, 20, v29
  v_mul_u32_u24 v30, 20, v29
  v_sub_u32 v30, v28, v30
  v_mul_u32_u24 v29, 40960, v29
  v_lshlrev_b32 v30, 10, v30
  v_add_u32 v29, v29, v30
  v_xor_b32 v30, v22, v23
  v_lshlrev_b32 v30, 4, v30
  v_add_u32 v29, v29, v30
  v_add_u32 v52, 16384, v29
  v_xor_b32 v53, 64, v52
  v_xor_b32 v54, 128, v52
  v_xor_b32 v55, 192, v52
  v_add_u32 v28, 64, v23
  v_mul_u32_u24 v29, 0xcccd, v28
  v_lshrrev_b32 v29, 20, v29
  v_mul_u32_u24 v30, 20, v29
  v_sub_u32 v30, v28, v30
  v_mul_u32_u24 v29, 40960, v29
  v_lshlrev_b32 v30, 10, v30
  v_add_u32 v29, v29, v30
  v_xor_b32 v30, v22, v23
  v_lshlrev_b32 v30, 4, v30
  v_add_u32 v29, v29, v30
  v_add_u32 v56, 16384, v29
  v_xor_b32 v57, 64, v56
  v_xor_b32 v58, 128, v56
  v_xor_b32 v59, 192, v56
  v_add_u32 v60, 129024, v32
  v_add_u32 v61, 193536, v33
  v_add_u32 v33, 64512, v33
  s_and_b32 s61, s29, 3
  s_lshl_b32 s3, s61, 20
  s_add_u32 s60, s61, 1
  s_and_b32 s60, s60, 3
  s_cmp_eq_u32 s60, 0
  s_mov_b32 s55, 256
  s_cselect_b32 s55, 0xfffffd00, s55
  s_add_u32 s60, s61, 2
  s_and_b32 s60, s60, 3
  s_cmp_eq_u32 s60, 0
  s_mov_b32 s56, 256
  s_cselect_b32 s56, 0xfffffd00, s56
  s_add_u32 s60, s61, 3
  s_and_b32 s60, s60, 3
  s_cmp_eq_u32 s60, 0
  s_mov_b32 s74, 256
  s_cselect_b32 s74, 0xfffffd00, s74
  s_lshl_b32 s61, s61, 8
  v_add_u32 v40, s61, v40
  v_add_u32 v41, s61, v41
  v_add_u32 v42, s61, v42
  v_add_u32 v43, s61, v43
  v_add_u32 v44, s61, v44
  v_add_u32 v45, s61, v45
  v_add_u32 v46, s61, v46
  v_add_u32 v47, s61, v47
  v_add_u32 v48, s61, v48
  v_add_u32 v49, s61, v49
  v_add_u32 v50, s61, v50
  v_add_u32 v51, s61, v51
  v_add_u32 v52, s61, v52
  v_add_u32 v53, s61, v53
  v_add_u32 v54, s61, v54
  v_add_u32 v55, s61, v55
  v_add_u32 v56, s61, v56
  v_add_u32 v57, s61, v57
  v_add_u32 v58, s61, v58
  v_add_u32 v59, s61, v59
  s_add_u32 m0, s52, 0
  s_nop 0
  buffer_load_dwordx4 v32, s[40:43], s3 offen  lds
  buffer_load_dwordx4 v33, s[40:43], s3 offen offset:1024  lds
  buffer_load_dwordx4 v60, s[40:43], s3 offen offset:2048  lds
  buffer_load_dwordx4 v61, s[40:43], s3 offen offset:3072  lds
  s_add_u32 s3, s3, 262144
  s_add_u32 m0, s52, 4096
  s_nop 0
  buffer_load_dwordx4 v32, s[40:43], s3 offen  lds
  buffer_load_dwordx4 v33, s[40:43], s3 offen offset:1024  lds
  buffer_load_dwordx4 v60, s[40:43], s3 offen offset:2048  lds
  buffer_load_dwordx4 v61, s[40:43], s3 offen offset:3072  lds
  s_add_u32 s3, s3, 262144
  s_add_u32 m0, s52, 8192
  s_nop 0
  buffer_load_dwordx4 v32, s[40:43], s3 offen  lds
  buffer_load_dwordx4 v33, s[40:43], s3 offen offset:1024  lds
  buffer_load_dwordx4 v60, s[40:43], s3 offen offset:2048  lds
  buffer_load_dwordx4 v61, s[40:43], s3 offen offset:3072  lds
  s_add_u32 s3, s3, 262144
  s_add_u32 m0, s52, 12288
  s_nop 0
  buffer_load_dwordx4 v32, s[40:43], s3 offen  lds
  buffer_load_dwordx4 v33, s[40:43], s3 offen offset:1024  lds
  buffer_load_dwordx4 v60, s[40:43], s3 offen offset:2048  lds
  buffer_load_dwordx4 v61, s[40:43], s3 offen offset:3072  lds
  s_add_u32 s3, s3, 262144
  s_and_b32 s3, s3, 0x3fffff
  s_waitcnt vmcnt(16)
  s_sub_u32 s73, 10, s73
  s_add_u32 s59, s72, s73
  s_lshl_b32 s61, s59, 4
  s_lshl_b32 s59, s59, 10
  s_lshl_b32 s60, s73, 10
  s_add_u32 s60, s60, s52
  s_add_u32 m0, s60, 16384
  s_and_b32 s62, s61, 0xf0
  v_xor_b32 v26, s62, v2
  s_add_u32 s61, s61, 16
  buffer_load_dwordx4 v26, s[44:47], s59 offen  lds
  s_and_b32 s62, s61, 0xf0
  v_xor_b32 v27, s62, v2
  s_add_u32 s61, s61, 16
  buffer_load_dwordx4 v27, s[44:47], s59 offen offset:1024  lds
  s_and_b32 s62, s61, 0xf0
  v_xor_b32 v26, s62, v2
  s_add_u32 s61, s61, 16
  buffer_load_dwordx4 v26, s[44:47], s59 offen offset:2048  lds
  s_and_b32 s62, s61, 0xf0
  v_xor_b32 v27, s62, v2
  s_add_u32 s61, s61, 16
  buffer_load_dwordx4 v27, s[44:47], s59 offen offset:3072  lds
  s_add_u32 m0, m0, 4096
  s_add_u32 s59, s59, 4096
  s_and_b32 s62, s61, 0xf0
  v_xor_b32 v26, s62, v2
  s_add_u32 s61, s61, 16
  buffer_load_dwordx4 v26, s[44:47], s59 offen  lds
  s_and_b32 s62, s61, 0xf0
  v_xor_b32 v27, s62, v2
  s_add_u32 s61, s61, 16
  buffer_load_dwordx4 v27, s[44:47], s59 offen offset:1024  lds
  s_and_b32 s62, s61, 0xf0
  v_xor_b32 v26, s62, v2
  s_add_u32 s61, s61, 16
  buffer_load_dwordx4 v26, s[44:47], s59 offen offset:2048  lds
  s_and_b32 s62, s61, 0xf0
  v_xor_b32 v27, s62, v2
  s_add_u32 s61, s61, 16
  buffer_load_dwordx4 v27, s[44:47], s59 offen offset:3072  lds
  s_add_u32 m0, m0, 4096
  s_add_u32 s59, s59, 4096
  s_and_b32 s62, s61, 0xf0
  v_xor_b32 v26, s62, v2
  s_add_u32 s61, s61, 16
  buffer_load_dwordx4 v26, s[44:47], s59 offen  lds
  s_and_b32 s62, s61, 0xf0
  v_xor_b32 v27, s62, v2
  s_add_u32 s61, s61, 16
  buffer_load_dwordx4 v27, s[44:47], s59 offen offset:1024  lds
  s_mov_b32 s62, s3
  s_waitcnt vmcnt(0)
  s_barrier
  s_cmp_eq_u32 s28, 0
  s_cselect_b32 s34, 0, s34
  s_cselect_b32 s38, 0, s38
  ds_read_b64_tr_b16 v[176:177], v34 offset:0
  ds_read_b64_tr_b16 v[178:179], v34 offset:512
  ds_read_b64_tr_b16 v[180:181], v35 offset:0
  ds_read_b64_tr_b16 v[182:183], v35 offset:512
  ds_read_b64_tr_b16 v[184:185], v36 offset:0
  ds_read_b64_tr_b16 v[186:187], v36 offset:512
  ds_read_b64_tr_b16 v[188:189], v37 offset:0
  ds_read_b64_tr_b16 v[190:191], v37 offset:512
  ds_read_b128 v[208:211], v40
  ds_read_b128 v[212:215], v44
  ds_read_b128 v[216:219], v48
  ds_read_b128 v[220:223], v52
  ds_read_b128 v[224:227], v56
  s_waitcnt lgkmcnt(0)
  v_mfma_f32_16x16x32_bf16 v[96:99], v[176:179], v[208:211], 0
  s_waitcnt vmcnt(8)
  v_mfma_f32_16x16x32_bf16 v[100:103], v[176:179], v[212:215], 0
  ds_read_b64_tr_b16 v[192:193], v34 offset:4096
  v_mfma_f32_16x16x32_bf16 v[104:107], v[176:179], v[216:219], 0
  ds_read_b64_tr_b16 v[194:195], v34 offset:4608
  v_mfma_f32_16x16x32_bf16 v[108:111], v[176:179], v[220:223], 0
  ds_read_b64_tr_b16 v[196:197], v35 offset:4096
  v_mfma_f32_16x16x32_bf16 v[112:115], v[176:179], v[224:227], 0
  ds_read_b64_tr_b16 v[198:199], v35 offset:4608
  v_mfma_f32_16x16x32_bf16 v[116:119], v[180:183], v[208:211], 0
  ds_read_b64_tr_b16 v[200:201], v36 offset:4096
  v_mfma_f32_16x16x32_bf16 v[120:123], v[180:183], v[212:215], 0
  ds_read_b64_tr_b16 v[202:203], v36 offset:4608
  v_mfma_f32_16x16x32_bf16 v[124:127], v[180:183], v[216:219], 0
  ds_read_b64_tr_b16 v[204:205], v37 offset:4096
  v_mfma_f32_16x16x32_bf16 v[128:131], v[180:183], v[220:223], 0
  ds_read_b64_tr_b16 v[206:207], v37 offset:4608
  s_add_u32 m0, s52, 0
  v_mfma_f32_16x16x32_bf16 v[132:135], v[180:183], v[224:227], 0
  ds_read_b128 v[228:231], v41
  s_nop 0
  v_mfma_f32_16x16x32_bf16 v[136:139], v[184:187], v[208:211], 0
  ds_read_b128 v[232:235], v45
  v_mfma_f32_16x16x32_bf16 v[140:143], v[184:187], v[212:215], 0
  ds_read_b128 v[236:239], v49
  buffer_load_dwordx4 v32, s[40:43], s62 offen  lds
  v_mfma_f32_16x16x32_bf16 v[144:147], v[184:187], v[216:219], 0
  ds_read_b128 v[240:243], v53
  buffer_load_dwordx4 v33, s[40:43], s62 offen offset:1024  lds
  v_mfma_f32_16x16x32_bf16 v[148:151], v[184:187], v[220:223], 0
  ds_read_b128 v[244:247], v57
  v_mfma_f32_16x16x32_bf16 v[152:155], v[184:187], v[224:227], 0
  buffer_load_dwordx4 v60, s[40:43], s62 offen offset:2048  lds
  v_mfma_f32_16x16x32_bf16 v[156:159], v[188:191], v[208:211], 0
  buffer_load_dwordx4 v61, s[40:43], s62 offen offset:3072  lds
  v_mfma_f32_16x16x32_bf16 v[160:163], v[188:191], v[212:215], 0
  v_mfma_f32_16x16x32_bf16 v[164:167], v[188:191], v[216:219], 0
  s_add_u32 s62, s62, 262144
  v_mfma_f32_16x16x32_bf16 v[168:171], v[188:191], v[220:223], 0
  s_and_b32 s62, s62, 0x3fffff
  v_mfma_f32_16x16x32_bf16 v[172:175], v[188:191], v[224:227], 0
  s_waitcnt lgkmcnt(0)
  v_mfma_f32_16x16x32_bf16 v[96:99], v[192:195], v[228:231], v[96:99]
  s_waitcnt vmcnt(8)
  v_mfma_f32_16x16x32_bf16 v[100:103], v[192:195], v[232:235], v[100:103]
  ds_read_b64_tr_b16 v[176:177], v34 offset:8192
  v_mfma_f32_16x16x32_bf16 v[104:107], v[192:195], v[236:239], v[104:107]
  ds_read_b64_tr_b16 v[178:179], v34 offset:8704
  v_mfma_f32_16x16x32_bf16 v[108:111], v[192:195], v[240:243], v[108:111]
  ds_read_b64_tr_b16 v[180:181], v35 offset:8192
  v_mfma_f32_16x16x32_bf16 v[112:115], v[192:195], v[244:247], v[112:115]
  ds_read_b64_tr_b16 v[182:183], v35 offset:8704
  v_mfma_f32_16x16x32_bf16 v[116:119], v[196:199], v[228:231], v[116:119]
  ds_read_b64_tr_b16 v[184:185], v36 offset:8192
  v_mfma_f32_16x16x32_bf16 v[120:123], v[196:199], v[232:235], v[120:123]
  ds_read_b64_tr_b16 v[186:187], v36 offset:8704
  v_mfma_f32_16x16x32_bf16 v[124:127], v[196:199], v[236:239], v[124:127]
  ds_read_b64_tr_b16 v[188:189], v37 offset:8192
  v_mfma_f32_16x16x32_bf16 v[128:131], v[196:199], v[240:243], v[128:131]
  ds_read_b64_tr_b16 v[190:191], v37 offset:8704
  s_add_u32 m0, s52, 4096
  v_mfma_f32_16x16x32_bf16 v[132:135], v[196:199], v[244:247], v[132:135]
  ds_read_b128 v[208:211], v42
  s_nop 0
  v_mfma_f32_16x16x32_bf16 v[136:139], v[200:203], v[228:231], v[136:139]
  ds_read_b128 v[212:215], v46
  v_mfma_f32_16x16x32_bf16 v[140:143], v[200:203], v[232:235], v[140:143]
  ds_read_b128 v[216:219], v50
  buffer_load_dwordx4 v32, s[40:43], s62 offen  lds
  v_mfma_f32_16x16x32_bf16 v[144:147], v[200:203], v[236:239], v[144:147]
  ds_read_b128 v[220:223], v54
  buffer_load_dwordx4 v33, s[40:43], s62 offen offset:1024  lds
  v_mfma_f32_16x16x32_bf16 v[148:151], v[200:203], v[240:243], v[148:151]
  ds_read_b128 v[224:227], v58
  v_mfma_f32_16x16x32_bf16 v[152:155], v[200:203], v[244:247], v[152:155]
  buffer_load_dwordx4 v60, s[40:43], s62 offen offset:2048  lds
  v_mfma_f32_16x16x32_bf16 v[156:159], v[204:207], v[228:231], v[156:159]
  buffer_load_dwordx4 v61, s[40:43], s62 offen offset:3072  lds
  v_mfma_f32_16x16x32_bf16 v[160:163], v[204:207], v[232:235], v[160:163]
  v_mfma_f32_16x16x32_bf16 v[164:167], v[204:207], v[236:239], v[164:167]
  s_add_u32 s62, s62, 262144
  v_mfma_f32_16x16x32_bf16 v[168:171], v[204:207], v[240:243], v[168:171]
  s_and_b32 s62, s62, 0x3fffff
  v_mfma_f32_16x16x32_bf16 v[172:175], v[204:207], v[244:247], v[172:175]
  s_waitcnt lgkmcnt(0)
  v_mfma_f32_16x16x32_bf16 v[96:99], v[176:179], v[208:211], v[96:99]
  s_waitcnt vmcnt(8)
  v_mfma_f32_16x16x32_bf16 v[100:103], v[176:179], v[212:215], v[100:103]
  ds_read_b64_tr_b16 v[192:193], v34 offset:12288
  v_mfma_f32_16x16x32_bf16 v[104:107], v[176:179], v[216:219], v[104:107]
  ds_read_b64_tr_b16 v[194:195], v34 offset:12800
  v_mfma_f32_16x16x32_bf16 v[108:111], v[176:179], v[220:223], v[108:111]
  ds_read_b64_tr_b16 v[196:197], v35 offset:12288
  v_mfma_f32_16x16x32_bf16 v[112:115], v[176:179], v[224:227], v[112:115]
  ds_read_b64_tr_b16 v[198:199], v35 offset:12800
  v_mfma_f32_16x16x32_bf16 v[116:119], v[180:183], v[208:211], v[116:119]
  ds_read_b64_tr_b16 v[200:201], v36 offset:12288
  v_mfma_f32_16x16x32_bf16 v[120:123], v[180:183], v[212:215], v[120:123]
  ds_read_b64_tr_b16 v[202:203], v36 offset:12800
  v_mfma_f32_16x16x32_bf16 v[124:127], v[180:183], v[216:219], v[124:127]
  ds_read_b64_tr_b16 v[204:205], v37 offset:12288
  v_mfma_f32_16x16x32_bf16 v[128:131], v[180:183], v[220:223], v[128:131]
  ds_read_b64_tr_b16 v[206:207], v37 offset:12800
  s_add_u32 m0, s52, 8192
  v_mfma_f32_16x16x32_bf16 v[132:135], v[180:183], v[224:227], v[132:135]
  ds_read_b128 v[228:231], v43
  s_nop 0
  v_mfma_f32_16x16x32_bf16 v[136:139], v[184:187], v[208:211], v[136:139]
  ds_read_b128 v[232:235], v47
  v_mfma_f32_16x16x32_bf16 v[140:143], v[184:187], v[212:215], v[140:143]
  ds_read_b128 v[236:239], v51
  buffer_load_dwordx4 v32, s[40:43], s62 offen  lds
  v_mfma_f32_16x16x32_bf16 v[144:147], v[184:187], v[216:219], v[144:147]
  ds_read_b128 v[240:243], v55
  buffer_load_dwordx4 v33, s[40:43], s62 offen offset:1024  lds
  v_mfma_f32_16x16x32_bf16 v[148:151], v[184:187], v[220:223], v[148:151]
  ds_read_b128 v[244:247], v59
  v_mfma_f32_16x16x32_bf16 v[152:155], v[184:187], v[224:227], v[152:155]
  buffer_load_dwordx4 v60, s[40:43], s62 offen offset:2048  lds
  v_mfma_f32_16x16x32_bf16 v[156:159], v[188:191], v[208:211], v[156:159]
  buffer_load_dwordx4 v61, s[40:43], s62 offen offset:3072  lds
  v_mfma_f32_16x16x32_bf16 v[160:163], v[188:191], v[212:215], v[160:163]
  v_mfma_f32_16x16x32_bf16 v[164:167], v[188:191], v[216:219], v[164:167]
  s_add_u32 s62, s62, 262144
  v_mfma_f32_16x16x32_bf16 v[168:171], v[188:191], v[220:223], v[168:171]
  s_and_b32 s62, s62, 0x3fffff
  v_mfma_f32_16x16x32_bf16 v[172:175], v[188:191], v[224:227], v[172:175]
  s_waitcnt lgkmcnt(0)
  v_mfma_f32_16x16x32_bf16 v[96:99], v[192:195], v[228:231], v[96:99]
  s_waitcnt vmcnt(8)
  v_mfma_f32_16x16x32_bf16 v[100:103], v[192:195], v[232:235], v[100:103]
  ds_read_b64_tr_b16 v[176:177], v34 offset:0
  ds_read_b64_tr_b16 v[178:179], v34 offset:512
  v_mfma_f32_16x16x32_bf16 v[104:107], v[192:195], v[236:239], v[104:107]
  ds_read_b64_tr_b16 v[180:181], v35 offset:0
  v_mfma_f32_16x16x32_bf16 v[108:111], v[192:195], v[240:243], v[108:111]
  ds_read_b64_tr_b16 v[182:183], v35 offset:512
  ds_read_b64_tr_b16 v[184:185], v36 offset:0
  v_mfma_f32_16x16x32_bf16 v[112:115], v[192:195], v[244:247], v[112:115]
  ds_read_b64_tr_b16 v[186:187], v36 offset:512
  v_mfma_f32_16x16x32_bf16 v[116:119], v[196:199], v[228:231], v[116:119]
  ds_read_b64_tr_b16 v[188:189], v37 offset:0
  v_mfma_f32_16x16x32_bf16 v[120:123], v[196:199], v[232:235], v[120:123]
  ds_read_b64_tr_b16 v[190:191], v37 offset:512
  v_add_u32 v40, s55, v40
  v_mfma_f32_16x16x32_bf16 v[124:127], v[196:199], v[236:239], v[124:127]
  v_add_u32 v44, s55, v44
  v_mfma_f32_16x16x32_bf16 v[128:131], v[196:199], v[240:243], v[128:131]
  v_add_u32 v48, s55, v48
  v_add_u32 v52, s55, v52
  s_add_u32 m0, s52, 12288
  v_mfma_f32_16x16x32_bf16 v[132:135], v[196:199], v[244:247], v[132:135]
  v_add_u32 v56, s55, v56
  s_nop 0
  v_mfma_f32_16x16x32_bf16 v[136:139], v[200:203], v[228:231], v[136:139]
  ds_read_b128 v[208:211], v40
  v_mfma_f32_16x16x32_bf16 v[140:143], v[200:203], v[232:235], v[140:143]
  ds_read_b128 v[212:215], v44
  ds_read_b128 v[216:219], v48
  buffer_load_dwordx4 v32, s[40:43], s62 offen  lds
  v_mfma_f32_16x16x32_bf16 v[144:147], v[200:203], v[236:239], v[144:147]
  ds_read_b128 v[220:223], v52
  buffer_load_dwordx4 v33, s[40:43], s62 offen offset:1024  lds
  v_mfma_f32_16x16x32_bf16 v[148:151], v[200:203], v[240:243], v[148:151]
  ds_read_b128 v[224:227], v56
  v_mfma_f32_16x16x32_bf16 v[152:155], v[200:203], v[244:247], v[152:155]
  buffer_load_dwordx4 v60, s[40:43], s62 offen offset:2048  lds
  v_mfma_f32_16x16x32_bf16 v[156:159], v[204:207], v[228:231], v[156:159]
  buffer_load_dwordx4 v61, s[40:43], s62 offen offset:3072  lds
  v_mfma_f32_16x16x32_bf16 v[160:163], v[204:207], v[232:235], v[160:163]
  v_mfma_f32_16x16x32_bf16 v[164:167], v[204:207], v[236:239], v[164:167]
  s_add_u32 s62, s62, 262144
  v_mfma_f32_16x16x32_bf16 v[168:171], v[204:207], v[240:243], v[168:171]
  s_and_b32 s62, s62, 0x3fffff
  v_mfma_f32_16x16x32_bf16 v[172:175], v[204:207], v[244:247], v[172:175]
  s_waitcnt lgkmcnt(0)
  v_mfma_f32_16x16x32_bf16 v[96:99], v[176:179], v[208:211], v[96:99]
  s_waitcnt vmcnt(8)
  v_mfma_f32_16x16x32_bf16 v[100:103], v[176:179], v[212:215], v[100:103]
  ds_read_b64_tr_b16 v[192:193], v34 offset:4096
  ds_read_b64_tr_b16 v[194:195], v34 offset:4608
  v_mfma_f32_16x16x32_bf16 v[104:107], v[176:179], v[216:219], v[104:107]
  ds_read_b64_tr_b16 v[196:197], v35 offset:4096
  v_mfma_f32_16x16x32_bf16 v[108:111], v[176:179], v[220:223], v[108:111]
  ds_read_b64_tr_b16 v[198:199], v35 offset:4608
  ds_read_b64_tr_b16 v[200:201], v36 offset:4096
  v_mfma_f32_16x16x32_bf16 v[112:115], v[176:179], v[224:227], v[112:115]
  ds_read_b64_tr_b16 v[202:203], v36 offset:4608
  v_mfma_f32_16x16x32_bf16 v[116:119], v[180:183], v[208:211], v[116:119]
  ds_read_b64_tr_b16 v[204:205], v37 offset:4096
  v_mfma_f32_16x16x32_bf16 v[120:123], v[180:183], v[212:215], v[120:123]
  ds_read_b64_tr_b16 v[206:207], v37 offset:4608
  v_add_u32 v41, s55, v41
  v_mfma_f32_16x16x32_bf16 v[124:127], v[180:183], v[216:219], v[124:127]
  v_add_u32 v45, s55, v45
  v_mfma_f32_16x16x32_bf16 v[128:131], v[180:183], v[220:223], v[128:131]
  v_add_u32 v49, s55, v49
  v_add_u32 v53, s55, v53
  s_add_u32 m0, s52, 0
  v_mfma_f32_16x16x32_bf16 v[132:135], v[180:183], v[224:227], v[132:135]
  v_add_u32 v57, s55, v57
  s_nop 0
  v_mfma_f32_16x16x32_bf16 v[136:139], v[184:187], v[208:211], v[136:139]
  ds_read_b128 v[228:231], v41
  v_mfma_f32_16x16x32_bf16 v[140:143], v[184:187], v[212:215], v[140:143]
  ds_read_b128 v[232:235], v45
  ds_read_b128 v[236:239], v49
  buffer_load_dwordx4 v32, s[40:43], s62 offen  lds
  v_mfma_f32_16x16x32_bf16 v[144:147], v[184:187], v[216:219], v[144:147]
  ds_read_b128 v[240:243], v53
  buffer_load_dwordx4 v33, s[40:43], s62 offen offset:1024  lds
  v_mfma_f32_16x16x32_bf16 v[148:151], v[184:187], v[220:223], v[148:151]
  ds_read_b128 v[244:247], v57
  v_mfma_f32_16x16x32_bf16 v[152:155], v[184:187], v[224:227], v[152:155]
  buffer_load_dwordx4 v60, s[40:43], s62 offen offset:2048  lds
  v_mfma_f32_16x16x32_bf16 v[156:159], v[188:191], v[208:211], v[156:159]
  buffer_load_dwordx4 v61, s[40:43], s62 offen offset:3072  lds
  v_mfma_f32_16x16x32_bf16 v[160:163], v[188:191], v[212:215], v[160:163]
  v_mfma_f32_16x16x32_bf16 v[164:167], v[188:191], v[216:219], v[164:167]
  s_add_u32 s62, s62, 262144
  v_mfma_f32_16x16x32_bf16 v[168:171], v[188:191], v[220:223], v[168:171]
  s_and_b32 s62, s62, 0x3fffff
  v_mfma_f32_16x16x32_bf16 v[172:175], v[188:191], v[224:227], v[172:175]
  s_waitcnt lgkmcnt(0)
  v_mfma_f32_16x16x32_bf16 v[96:99], v[192:195], v[228:231], v[96:99]
  s_waitcnt vmcnt(8)
  v_mfma_f32_16x16x32_bf16 v[100:103], v[192:195], v[232:235], v[100:103]
  ds_read_b64_tr_b16 v[176:177], v34 offset:8192
  ds_read_b64_tr_b16 v[178:179], v34 offset:8704
  v_mfma_f32_16x16x32_bf16 v[104:107], v[192:195], v[236:239], v[104:107]
  ds_read_b64_tr_b16 v[180:181], v35 offset:8192
  v_mfma_f32_16x16x32_bf16 v[108:111], v[192:195], v[240:243], v[108:111]
  ds_read_b64_tr_b16 v[182:183], v35 offset:8704
  ds_read_b64_tr_b16 v[184:185], v36 offset:8192
  v_mfma_f32_16x16x32_bf16 v[112:115], v[192:195], v[244:247], v[112:115]
  ds_read_b64_tr_b16 v[186:187], v36 offset:8704
  v_mfma_f32_16x16x32_bf16 v[116:119], v[196:199], v[228:231], v[116:119]
  ds_read_b64_tr_b16 v[188:189], v37 offset:8192
  v_mfma_f32_16x16x32_bf16 v[120:123], v[196:199], v[232:235], v[120:123]
  ds_read_b64_tr_b16 v[190:191], v37 offset:8704
  v_add_u32 v42, s55, v42
  v_mfma_f32_16x16x32_bf16 v[124:127], v[196:199], v[236:239], v[124:127]
  v_add_u32 v46, s55, v46
  v_mfma_f32_16x16x32_bf16 v[128:131], v[196:199], v[240:243], v[128:131]
  v_add_u32 v50, s55, v50
  v_add_u32 v54, s55, v54
  s_add_u32 m0, s52, 4096
  v_mfma_f32_16x16x32_bf16 v[132:135], v[196:199], v[244:247], v[132:135]
  v_add_u32 v58, s55, v58
  s_nop 0
  v_mfma_f32_16x16x32_bf16 v[136:139], v[200:203], v[228:231], v[136:139]
  ds_read_b128 v[208:211], v42
  v_mfma_f32_16x16x32_bf16 v[140:143], v[200:203], v[232:235], v[140:143]
  ds_read_b128 v[212:215], v46
  ds_read_b128 v[216:219], v50
  buffer_load_dwordx4 v32, s[40:43], s62 offen  lds
  v_mfma_f32_16x16x32_bf16 v[144:147], v[200:203], v[236:239], v[144:147]
  ds_read_b128 v[220:223], v54
  buffer_load_dwordx4 v33, s[40:43], s62 offen offset:1024  lds
  v_mfma_f32_16x16x32_bf16 v[148:151], v[200:203], v[240:243], v[148:151]
  ds_read_b128 v[224:227], v58
  v_mfma_f32_16x16x32_bf16 v[152:155], v[200:203], v[244:247], v[152:155]
  buffer_load_dwordx4 v60, s[40:43], s62 offen offset:2048  lds
  v_mfma_f32_16x16x32_bf16 v[156:159], v[204:207], v[228:231], v[156:159]
  buffer_load_dwordx4 v61, s[40:43], s62 offen offset:3072  lds
  v_mfma_f32_16x16x32_bf16 v[160:163], v[204:207], v[232:235], v[160:163]
  v_mfma_f32_16x16x32_bf16 v[164:167], v[204:207], v[236:239], v[164:167]
  s_add_u32 s62, s62, 262144
  v_mfma_f32_16x16x32_bf16 v[168:171], v[204:207], v[240:243], v[168:171]
  s_and_b32 s62, s62, 0x3fffff
  v_mfma_f32_16x16x32_bf16 v[172:175], v[204:207], v[244:247], v[172:175]
  s_waitcnt lgkmcnt(0)
  v_mfma_f32_16x16x32_bf16 v[96:99], v[176:179], v[208:211], v[96:99]
  s_waitcnt vmcnt(8)
  v_mfma_f32_16x16x32_bf16 v[100:103], v[176:179], v[212:215], v[100:103]
  ds_read_b64_tr_b16 v[192:193], v34 offset:12288
  ds_read_b64_tr_b16 v[194:195], v34 offset:12800
  v_mfma_f32_16x16x32_bf16 v[104:107], v[176:179], v[216:219], v[104:107]
  ds_read_b64_tr_b16 v[196:197], v35 offset:12288
  v_mfma_f32_16x16x32_bf16 v[108:111], v[176:179], v[220:223], v[108:111]
  ds_read_b64_tr_b16 v[198:199], v35 offset:12800
  ds_read_b64_tr_b16 v[200:201], v36 offset:12288
  v_mfma_f32_16x16x32_bf16 v[112:115], v[176:179], v[224:227], v[112:115]
  ds_read_b64_tr_b16 v[202:203], v36 offset:12800
  v_mfma_f32_16x16x32_bf16 v[116:119], v[180:183], v[208:211], v[116:119]
  ds_read_b64_tr_b16 v[204:205], v37 offset:12288
  v_mfma_f32_16x16x32_bf16 v[120:123], v[180:183], v[212:215], v[120:123]
  ds_read_b64_tr_b16 v[206:207], v37 offset:12800
  v_add_u32 v43, s55, v43
  v_mfma_f32_16x16x32_bf16 v[124:127], v[180:183], v[216:219], v[124:127]
  v_add_u32 v47, s55, v47
  v_mfma_f32_16x16x32_bf16 v[128:131], v[180:183], v[220:223], v[128:131]
  v_add_u32 v51, s55, v51
  v_add_u32 v55, s55, v55
  s_add_u32 m0, s52, 8192
  v_mfma_f32_16x16x32_bf16 v[132:135], v[180:183], v[224:227], v[132:135]
  v_add_u32 v59, s55, v59
  s_nop 0
  v_mfma_f32_16x16x32_bf16 v[136:139], v[184:187], v[208:211], v[136:139]
  ds_read_b128 v[228:231], v43
  v_mfma_f32_16x16x32_bf16 v[140:143], v[184:187], v[212:215], v[140:143]
  ds_read_b128 v[232:235], v47
  ds_read_b128 v[236:239], v51
  buffer_load_dwordx4 v32, s[40:43], s62 offen  lds
  v_mfma_f32_16x16x32_bf16 v[144:147], v[184:187], v[216:219], v[144:147]
  ds_read_b128 v[240:243], v55
  buffer_load_dwordx4 v33, s[40:43], s62 offen offset:1024  lds
  v_mfma_f32_16x16x32_bf16 v[148:151], v[184:187], v[220:223], v[148:151]
  ds_read_b128 v[244:247], v59
  v_mfma_f32_16x16x32_bf16 v[152:155], v[184:187], v[224:227], v[152:155]
  buffer_load_dwordx4 v60, s[40:43], s62 offen offset:2048  lds
  v_mfma_f32_16x16x32_bf16 v[156:159], v[188:191], v[208:211], v[156:159]
  buffer_load_dwordx4 v61, s[40:43], s62 offen offset:3072  lds
  v_mfma_f32_16x16x32_bf16 v[160:163], v[188:191], v[212:215], v[160:163]
  v_mfma_f32_16x16x32_bf16 v[164:167], v[188:191], v[216:219], v[164:167]
  s_add_u32 s62, s62, 262144
  v_mfma_f32_16x16x32_bf16 v[168:171], v[188:191], v[220:223], v[168:171]
  s_and_b32 s62, s62, 0x3fffff
  v_mfma_f32_16x16x32_bf16 v[172:175], v[188:191], v[224:227], v[172:175]
  s_waitcnt lgkmcnt(0)
  v_mfma_f32_16x16x32_bf16 v[96:99], v[192:195], v[228:231], v[96:99]
  s_waitcnt vmcnt(8)
  v_mfma_f32_16x16x32_bf16 v[100:103], v[192:195], v[232:235], v[100:103]
  ds_read_b64_tr_b16 v[176:177], v34 offset:0
  ds_read_b64_tr_b16 v[178:179], v34 offset:512
  v_mfma_f32_16x16x32_bf16 v[104:107], v[192:195], v[236:239], v[104:107]
  ds_read_b64_tr_b16 v[180:181], v35 offset:0
  v_mfma_f32_16x16x32_bf16 v[108:111], v[192:195], v[240:243], v[108:111]
  ds_read_b64_tr_b16 v[182:183], v35 offset:512
  ds_read_b64_tr_b16 v[184:185], v36 offset:0
  v_mfma_f32_16x16x32_bf16 v[112:115], v[192:195], v[244:247], v[112:115]
  ds_read_b64_tr_b16 v[186:187], v36 offset:512
  v_mfma_f32_16x16x32_bf16 v[116:119], v[196:199], v[228:231], v[116:119]
  ds_read_b64_tr_b16 v[188:189], v37 offset:0
  v_mfma_f32_16x16x32_bf16 v[120:123], v[196:199], v[232:235], v[120:123]
  ds_read_b64_tr_b16 v[190:191], v37 offset:512
  v_add_u32 v40, s56, v40
  v_mfma_f32_16x16x32_bf16 v[124:127], v[196:199], v[236:239], v[124:127]
  v_add_u32 v44, s56, v44
  v_mfma_f32_16x16x32_bf16 v[128:131], v[196:199], v[240:243], v[128:131]
  v_add_u32 v48, s56, v48
  v_add_u32 v52, s56, v52
  s_add_u32 m0, s52, 12288
  v_mfma_f32_16x16x32_bf16 v[132:135], v[196:199], v[244:247], v[132:135]
  v_add_u32 v56, s56, v56
  s_nop 0
  v_mfma_f32_16x16x32_bf16 v[136:139], v[200:203], v[228:231], v[136:139]
  ds_read_b128 v[208:211], v40
  v_mfma_f32_16x16x32_bf16 v[140:143], v[200:203], v[232:235], v[140:143]
  ds_read_b128 v[212:215], v44
  ds_read_b128 v[216:219], v48
  buffer_load_dwordx4 v32, s[40:43], s62 offen  lds
  v_mfma_f32_16x16x32_bf16 v[144:147], v[200:203], v[236:239], v[144:147]
  ds_read_b128 v[220:223], v52
  buffer_load_dwordx4 v33, s[40:43], s62 offen offset:1024  lds
  v_mfma_f32_16x16x32_bf16 v[148:151], v[200:203], v[240:243], v[148:151]
  ds_read_b128 v[224:227], v56
  v_mfma_f32_16x16x32_bf16 v[152:155], v[200:203], v[244:247], v[152:155]
  buffer_load_dwordx4 v60, s[40:43], s62 offen offset:2048  lds
  v_mfma_f32_16x16x32_bf16 v[156:159], v[204:207], v[228:231], v[156:159]
  buffer_load_dwordx4 v61, s[40:43], s62 offen offset:3072  lds
  v_mfma_f32_16x16x32_bf16 v[160:163], v[204:207], v[232:235], v[160:163]
  v_mfma_f32_16x16x32_bf16 v[164:167], v[204:207], v[236:239], v[164:167]
  s_add_u32 s62, s62, 262144
  v_mfma_f32_16x16x32_bf16 v[168:171], v[204:207], v[240:243], v[168:171]
  s_and_b32 s62, s62, 0x3fffff
  v_mfma_f32_16x16x32_bf16 v[172:175], v[204:207], v[244:247], v[172:175]
  s_waitcnt lgkmcnt(0)
  v_mfma_f32_16x16x32_bf16 v[96:99], v[176:179], v[208:211], v[96:99]
  s_waitcnt vmcnt(8)
  v_mfma_f32_16x16x32_bf16 v[100:103], v[176:179], v[212:215], v[100:103]
  ds_read_b64_tr_b16 v[192:193], v34 offset:4096
  ds_read_b64_tr_b16 v[194:195], v34 offset:4608
  v_mfma_f32_16x16x32_bf16 v[104:107], v[176:179], v[216:219], v[104:107]
  ds_read_b64_tr_b16 v[196:197], v35 offset:4096
  v_mfma_f32_16x16x32_bf16 v[108:111], v[176:179], v[220:223], v[108:111]
  ds_read_b64_tr_b16 v[198:199], v35 offset:4608
  ds_read_b64_tr_b16 v[200:201], v36 offset:4096
  v_mfma_f32_16x16x32_bf16 v[112:115], v[176:179], v[224:227], v[112:115]
  ds_read_b64_tr_b16 v[202:203], v36 offset:4608
  v_mfma_f32_16x16x32_bf16 v[116:119], v[180:183], v[208:211], v[116:119]
  ds_read_b64_tr_b16 v[204:205], v37 offset:4096
  v_mfma_f32_16x16x32_bf16 v[120:123], v[180:183], v[212:215], v[120:123]
  ds_read_b64_tr_b16 v[206:207], v37 offset:4608
  v_add_u32 v41, s56, v41
  v_mfma_f32_16x16x32_bf16 v[124:127], v[180:183], v[216:219], v[124:127]
  v_add_u32 v45, s56, v45
  v_mfma_f32_16x16x32_bf16 v[128:131], v[180:183], v[220:223], v[128:131]
  v_add_u32 v49, s56, v49
  v_add_u32 v53, s56, v53
  s_add_u32 m0, s52, 0
  v_mfma_f32_16x16x32_bf16 v[132:135], v[180:183], v[224:227], v[132:135]
  v_add_u32 v57, s56, v57
  s_nop 0
  v_mfma_f32_16x16x32_bf16 v[136:139], v[184:187], v[208:211], v[136:139]
  ds_read_b128 v[228:231], v41
  v_mfma_f32_16x16x32_bf16 v[140:143], v[184:187], v[212:215], v[140:143]
  ds_read_b128 v[232:235], v45
  ds_read_b128 v[236:239], v49
  buffer_load_dwordx4 v32, s[40:43], s62 offen  lds
  v_mfma_f32_16x16x32_bf16 v[144:147], v[184:187], v[216:219], v[144:147]
  ds_read_b128 v[240:243], v53
  buffer_load_dwordx4 v33, s[40:43], s62 offen offset:1024  lds
  v_mfma_f32_16x16x32_bf16 v[148:151], v[184:187], v[220:223], v[148:151]
  ds_read_b128 v[244:247], v57
  v_mfma_f32_16x16x32_bf16 v[152:155], v[184:187], v[224:227], v[152:155]
  buffer_load_dwordx4 v60, s[40:43], s62 offen offset:2048  lds
  v_mfma_f32_16x16x32_bf16 v[156:159], v[188:191], v[208:211], v[156:159]
  buffer_load_dwordx4 v61, s[40:43], s62 offen offset:3072  lds
  v_mfma_f32_16x16x32_bf16 v[160:163], v[188:191], v[212:215], v[160:163]
  v_mfma_f32_16x16x32_bf16 v[164:167], v[188:191], v[216:219], v[164:167]
  s_add_u32 s62, s62, 262144
  v_mfma_f32_16x16x32_bf16 v[168:171], v[188:191], v[220:223], v[168:171]
  s_and_b32 s62, s62, 0x3fffff
  v_mfma_f32_16x16x32_bf16 v[172:175], v[188:191], v[224:227], v[172:175]
  s_waitcnt lgkmcnt(0)
  v_mfma_f32_16x16x32_bf16 v[96:99], v[192:195], v[228:231], v[96:99]
  s_waitcnt vmcnt(8)
  v_mfma_f32_16x16x32_bf16 v[100:103], v[192:195], v[232:235], v[100:103]
  ds_read_b64_tr_b16 v[176:177], v34 offset:8192
  ds_read_b64_tr_b16 v[178:179], v34 offset:8704
  v_mfma_f32_16x16x32_bf16 v[104:107], v[192:195], v[236:239], v[104:107]
  ds_read_b64_tr_b16 v[180:181], v35 offset:8192
  v_mfma_f32_16x16x32_bf16 v[108:111], v[192:195], v[240:243], v[108:111]
  ds_read_b64_tr_b16 v[182:183], v35 offset:8704
  ds_read_b64_tr_b16 v[184:185], v36 offset:8192
  v_mfma_f32_16x16x32_bf16 v[112:115], v[192:195], v[244:247], v[112:115]
  ds_read_b64_tr_b16 v[186:187], v36 offset:8704
  v_mfma_f32_16x16x32_bf16 v[116:119], v[196:199], v[228:231], v[116:119]
  ds_read_b64_tr_b16 v[188:189], v37 offset:8192
  v_mfma_f32_16x16x32_bf16 v[120:123], v[196:199], v[232:235], v[120:123]
  ds_read_b64_tr_b16 v[190:191], v37 offset:8704
  v_add_u32 v42, s56, v42
  v_mfma_f32_16x16x32_bf16 v[124:127], v[196:199], v[236:239], v[124:127]
  v_add_u32 v46, s56, v46
  v_mfma_f32_16x16x32_bf16 v[128:131], v[196:199], v[240:243], v[128:131]
  v_add_u32 v50, s56, v50
  v_add_u32 v54, s56, v54
  s_add_u32 m0, s52, 4096
  v_mfma_f32_16x16x32_bf16 v[132:135], v[196:199], v[244:247], v[132:135]
  v_add_u32 v58, s56, v58
  s_nop 0
  v_mfma_f32_16x16x32_bf16 v[136:139], v[200:203], v[228:231], v[136:139]
  ds_read_b128 v[208:211], v42
  v_mfma_f32_16x16x32_bf16 v[140:143], v[200:203], v[232:235], v[140:143]
  ds_read_b128 v[212:215], v46
  ds_read_b128 v[216:219], v50
  buffer_load_dwordx4 v32, s[40:43], s62 offen  lds
  v_mfma_f32_16x16x32_bf16 v[144:147], v[200:203], v[236:239], v[144:147]
  ds_read_b128 v[220:223], v54
  buffer_load_dwordx4 v33, s[40:43], s62 offen offset:1024  lds
  v_mfma_f32_16x16x32_bf16 v[148:151], v[200:203], v[240:243], v[148:151]
  ds_read_b128 v[224:227], v58
  v_mfma_f32_16x16x32_bf16 v[152:155], v[200:203], v[244:247], v[152:155]
  buffer_load_dwordx4 v60, s[40:43], s62 offen offset:2048  lds
  v_mfma_f32_16x16x32_bf16 v[156:159], v[204:207], v[228:231], v[156:159]
  buffer_load_dwordx4 v61, s[40:43], s62 offen offset:3072  lds
  v_mfma_f32_16x16x32_bf16 v[160:163], v[204:207], v[232:235], v[160:163]
  v_mfma_f32_16x16x32_bf16 v[164:167], v[204:207], v[236:239], v[164:167]
  s_add_u32 s62, s62, 262144
  v_mfma_f32_16x16x32_bf16 v[168:171], v[204:207], v[240:243], v[168:171]
  s_and_b32 s62, s62, 0x3fffff
  v_mfma_f32_16x16x32_bf16 v[172:175], v[204:207], v[244:247], v[172:175]
  s_waitcnt lgkmcnt(0)
  v_mfma_f32_16x16x32_bf16 v[96:99], v[176:179], v[208:211], v[96:99]
  s_waitcnt vmcnt(8)
  v_mfma_f32_16x16x32_bf16 v[100:103], v[176:179], v[212:215], v[100:103]
  ds_read_b64_tr_b16 v[192:193], v34 offset:12288
  ds_read_b64_tr_b16 v[194:195], v34 offset:12800
  v_mfma_f32_16x16x32_bf16 v[104:107], v[176:179], v[216:219], v[104:107]
  ds_read_b64_tr_b16 v[196:197], v35 offset:12288
  v_mfma_f32_16x16x32_bf16 v[108:111], v[176:179], v[220:223], v[108:111]
  ds_read_b64_tr_b16 v[198:199], v35 offset:12800
  ds_read_b64_tr_b16 v[200:201], v36 offset:12288
  v_mfma_f32_16x16x32_bf16 v[112:115], v[176:179], v[224:227], v[112:115]
  ds_read_b64_tr_b16 v[202:203], v36 offset:12800
  v_mfma_f32_16x16x32_bf16 v[116:119], v[180:183], v[208:211], v[116:119]
  ds_read_b64_tr_b16 v[204:205], v37 offset:12288
  v_mfma_f32_16x16x32_bf16 v[120:123], v[180:183], v[212:215], v[120:123]
  ds_read_b64_tr_b16 v[206:207], v37 offset:12800
  v_add_u32 v43, s56, v43
  v_mfma_f32_16x16x32_bf16 v[124:127], v[180:183], v[216:219], v[124:127]
  v_add_u32 v47, s56, v47
  v_mfma_f32_16x16x32_bf16 v[128:131], v[180:183], v[220:223], v[128:131]
  v_add_u32 v51, s56, v51
  v_add_u32 v55, s56, v55
  s_add_u32 m0, s52, 8192
  v_mfma_f32_16x16x32_bf16 v[132:135], v[180:183], v[224:227], v[132:135]
  v_add_u32 v59, s56, v59
  s_nop 0
  v_mfma_f32_16x16x32_bf16 v[136:139], v[184:187], v[208:211], v[136:139]
  ds_read_b128 v[228:231], v43
  v_mfma_f32_16x16x32_bf16 v[140:143], v[184:187], v[212:215], v[140:143]
  ds_read_b128 v[232:235], v47
  ds_read_b128 v[236:239], v51
  buffer_load_dwordx4 v32, s[40:43], s62 offen  lds
  v_mfma_f32_16x16x32_bf16 v[144:147], v[184:187], v[216:219], v[144:147]
  ds_read_b128 v[240:243], v55
  buffer_load_dwordx4 v33, s[40:43], s62 offen offset:1024  lds
  v_mfma_f32_16x16x32_bf16 v[148:151], v[184:187], v[220:223], v[148:151]
  ds_read_b128 v[244:247], v59
  v_mfma_f32_16x16x32_bf16 v[152:155], v[184:187], v[224:227], v[152:155]
  buffer_load_dwordx4 v60, s[40:43], s62 offen offset:2048  lds
  v_mfma_f32_16x16x32_bf16 v[156:159], v[188:191], v[208:211], v[156:159]
  buffer_load_dwordx4 v61, s[40:43], s62 offen offset:3072  lds
  v_mfma_f32_16x16x32_bf16 v[160:163], v[188:191], v[212:215], v[160:163]
  v_mfma_f32_16x16x32_bf16 v[164:167], v[188:191], v[216:219], v[164:167]
  s_add_u32 s62, s62, 262144
  v_mfma_f32_16x16x32_bf16 v[168:171], v[188:191], v[220:223], v[168:171]
  s_and_b32 s62, s62, 0x3fffff
  v_mfma_f32_16x16x32_bf16 v[172:175], v[188:191], v[224:227], v[172:175]
  s_waitcnt lgkmcnt(0)
  v_mfma_f32_16x16x32_bf16 v[96:99], v[192:195], v[228:231], v[96:99]
  s_waitcnt vmcnt(8)
  v_mfma_f32_16x16x32_bf16 v[100:103], v[192:195], v[232:235], v[100:103]
  ds_read_b64_tr_b16 v[176:177], v34 offset:0
  ds_read_b64_tr_b16 v[178:179], v34 offset:512
  v_mfma_f32_16x16x32_bf16 v[104:107], v[192:195], v[236:239], v[104:107]
  ds_read_b64_tr_b16 v[180:181], v35 offset:0
  v_mfma_f32_16x16x32_bf16 v[108:111], v[192:195], v[240:243], v[108:111]
  ds_read_b64_tr_b16 v[182:183], v35 offset:512
  ds_read_b64_tr_b16 v[184:185], v36 offset:0
  v_mfma_f32_16x16x32_bf16 v[112:115], v[192:195], v[244:247], v[112:115]
  ds_read_b64_tr_b16 v[186:187], v36 offset:512
  v_mfma_f32_16x16x32_bf16 v[116:119], v[196:199], v[228:231], v[116:119]
  ds_read_b64_tr_b16 v[188:189], v37 offset:0
  v_mfma_f32_16x16x32_bf16 v[120:123], v[196:199], v[232:235], v[120:123]
  ds_read_b64_tr_b16 v[190:191], v37 offset:512
  v_add_u32 v40, s74, v40
  v_mfma_f32_16x16x32_bf16 v[124:127], v[196:199], v[236:239], v[124:127]
  v_add_u32 v44, s74, v44
  v_mfma_f32_16x16x32_bf16 v[128:131], v[196:199], v[240:243], v[128:131]
  v_add_u32 v48, s74, v48
  v_add_u32 v52, s74, v52
  s_add_u32 m0, s52, 12288
  v_mfma_f32_16x16x32_bf16 v[132:135], v[196:199], v[244:247], v[132:135]
  v_add_u32 v56, s74, v56
  s_nop 0
  v_mfma_f32_16x16x32_bf16 v[136:139], v[200:203], v[228:231], v[136:139]
  ds_read_b128 v[208:211], v40
  v_mfma_f32_16x16x32_bf16 v[140:143], v[200:203], v[232:235], v[140:143]
  ds_read_b128 v[212:215], v44
  ds_read_b128 v[216:219], v48
  buffer_load_dwordx4 v32, s[40:43], s62 offen  lds
  v_mfma_f32_16x16x32_bf16 v[144:147], v[200:203], v[236:239], v[144:147]
  ds_read_b128 v[220:223], v52
  buffer_load_dwordx4 v33, s[40:43], s62 offen offset:1024  lds
  v_mfma_f32_16x16x32_bf16 v[148:151], v[200:203], v[240:243], v[148:151]
  ds_read_b128 v[224:227], v56
  v_mfma_f32_16x16x32_bf16 v[152:155], v[200:203], v[244:247], v[152:155]
  buffer_load_dwordx4 v60, s[40:43], s62 offen offset:2048  lds
  v_mfma_f32_16x16x32_bf16 v[156:159], v[204:207], v[228:231], v[156:159]
  buffer_load_dwordx4 v61, s[40:43], s62 offen offset:3072  lds
  v_mfma_f32_16x16x32_bf16 v[160:163], v[204:207], v[232:235], v[160:163]
  v_mfma_f32_16x16x32_bf16 v[164:167], v[204:207], v[236:239], v[164:167]
  s_add_u32 s62, s62, 262144
  v_mfma_f32_16x16x32_bf16 v[168:171], v[204:207], v[240:243], v[168:171]
  s_and_b32 s62, s62, 0x3fffff
  v_mfma_f32_16x16x32_bf16 v[172:175], v[204:207], v[244:247], v[172:175]
  s_waitcnt lgkmcnt(0)
  v_mfma_f32_16x16x32_bf16 v[96:99], v[176:179], v[208:211], v[96:99]
  s_waitcnt vmcnt(8)
  v_mfma_f32_16x16x32_bf16 v[100:103], v[176:179], v[212:215], v[100:103]
  ds_read_b64_tr_b16 v[192:193], v34 offset:4096
  ds_read_b64_tr_b16 v[194:195], v34 offset:4608
  v_mfma_f32_16x16x32_bf16 v[104:107], v[176:179], v[216:219], v[104:107]
  ds_read_b64_tr_b16 v[196:197], v35 offset:4096
  v_mfma_f32_16x16x32_bf16 v[108:111], v[176:179], v[220:223], v[108:111]
  ds_read_b64_tr_b16 v[198:199], v35 offset:4608
  ds_read_b64_tr_b16 v[200:201], v36 offset:4096
  v_mfma_f32_16x16x32_bf16 v[112:115], v[176:179], v[224:227], v[112:115]
  ds_read_b64_tr_b16 v[202:203], v36 offset:4608
  v_mfma_f32_16x16x32_bf16 v[116:119], v[180:183], v[208:211], v[116:119]
  ds_read_b64_tr_b16 v[204:205], v37 offset:4096
  v_mfma_f32_16x16x32_bf16 v[120:123], v[180:183], v[212:215], v[120:123]
  ds_read_b64_tr_b16 v[206:207], v37 offset:4608
  v_add_u32 v41, s74, v41
  v_mfma_f32_16x16x32_bf16 v[124:127], v[180:183], v[216:219], v[124:127]
  v_add_u32 v45, s74, v45
  v_mfma_f32_16x16x32_bf16 v[128:131], v[180:183], v[220:223], v[128:131]
  v_add_u32 v49, s74, v49
  v_add_u32 v53, s74, v53
  v_mfma_f32_16x16x32_bf16 v[132:135], v[180:183], v[224:227], v[132:135]
  v_add_u32 v57, s74, v57
  v_mfma_f32_16x16x32_bf16 v[136:139], v[184:187], v[208:211], v[136:139]
  ds_read_b128 v[228:231], v41
  v_mfma_f32_16x16x32_bf16 v[140:143], v[184:187], v[212:215], v[140:143]
  ds_read_b128 v[232:235], v45
  ds_read_b128 v[236:239], v49
  v_mfma_f32_16x16x32_bf16 v[144:147], v[184:187], v[216:219], v[144:147]
  ds_read_b128 v[240:243], v53
  v_mfma_f32_16x16x32_bf16 v[148:151], v[184:187], v[220:223], v[148:151]
  ds_read_b128 v[244:247], v57
  v_mfma_f32_16x16x32_bf16 v[152:155], v[184:187], v[224:227], v[152:155]
  v_mfma_f32_16x16x32_bf16 v[156:159], v[188:191], v[208:211], v[156:159]
  v_mfma_f32_16x16x32_bf16 v[160:163], v[188:191], v[212:215], v[160:163]
  v_mfma_f32_16x16x32_bf16 v[164:167], v[188:191], v[216:219], v[164:167]
  v_mfma_f32_16x16x32_bf16 v[168:171], v[188:191], v[220:223], v[168:171]
  v_mfma_f32_16x16x32_bf16 v[172:175], v[188:191], v[224:227], v[172:175]
  s_waitcnt lgkmcnt(0)
  v_mfma_f32_16x16x32_bf16 v[96:99], v[192:195], v[228:231], v[96:99]
  s_waitcnt vmcnt(4)
  v_mfma_f32_16x16x32_bf16 v[100:103], v[192:195], v[232:235], v[100:103]
  ds_read_b64_tr_b16 v[176:177], v34 offset:8192
  ds_read_b64_tr_b16 v[178:179], v34 offset:8704
  v_mfma_f32_16x16x32_bf16 v[104:107], v[192:195], v[236:239], v[104:107]
  ds_read_b64_tr_b16 v[180:181], v35 offset:8192
  v_mfma_f32_16x16x32_bf16 v[108:111], v[192:195], v[240:243], v[108:111]
  ds_read_b64_tr_b16 v[182:183], v35 offset:8704
  ds_read_b64_tr_b16 v[184:185], v36 offset:8192
  v_mfma_f32_16x16x32_bf16 v[112:115], v[192:195], v[244:247], v[112:115]
  ds_read_b64_tr_b16 v[186:187], v36 offset:8704
  v_mfma_f32_16x16x32_bf16 v[116:119], v[196:199], v[228:231], v[116:119]
  ds_read_b64_tr_b16 v[188:189], v37 offset:8192
  v_mfma_f32_16x16x32_bf16 v[120:123], v[196:199], v[232:235], v[120:123]
  ds_read_b64_tr_b16 v[190:191], v37 offset:8704
  v_add_u32 v42, s74, v42
  v_mfma_f32_16x16x32_bf16 v[124:127], v[196:199], v[236:239], v[124:127]
  v_add_u32 v46, s74, v46
  v_mfma_f32_16x16x32_bf16 v[128:131], v[196:199], v[240:243], v[128:131]
  v_add_u32 v50, s74, v50
  v_add_u32 v54, s74, v54
  s_mov_b32 s62, s70
  s_mov_b32 m0, s52
  v_mfma_f32_16x16x32_bf16 v[132:135], v[196:199], v[244:247], v[132:135]
  v_add_u32 v58, s74, v58
  s_add_u32 s60, s62, 4096
  v_mfma_f32_16x16x32_bf16 v[136:139], v[200:203], v[228:231], v[136:139]
  ds_read_b128 v[208:211], v42
  buffer_load_dwordx4 v16, s[32:35], s62 offen nt lds
  v_mfma_f32_16x16x32_bf16 v[140:143], v[200:203], v[232:235], v[140:143]
  ds_read_b128 v[212:215], v46
  ds_read_b128 v[216:219], v50
  buffer_load_dwordx4 v17, s[32:35], s62 offen offset:1024 nt lds
  v_mfma_f32_16x16x32_bf16 v[144:147], v[200:203], v[236:239], v[144:147]
  ds_read_b128 v[220:223], v54
  buffer_load_dwordx4 v18, s[32:35], s62 offen offset:2048 nt lds
  v_mfma_f32_16x16x32_bf16 v[148:151], v[200:203], v[240:243], v[148:151]
  ds_read_b128 v[224:227], v58
  buffer_load_dwordx4 v19, s[32:35], s62 offen offset:3072 nt lds
  v_mfma_f32_16x16x32_bf16 v[152:155], v[200:203], v[244:247], v[152:155]
  s_add_u32 m0, m0, 4096
  v_mfma_f32_16x16x32_bf16 v[156:159], v[204:207], v[228:231], v[156:159]
  s_nop 0
  v_mfma_f32_16x16x32_bf16 v[160:163], v[204:207], v[232:235], v[160:163]
  buffer_load_dwordx4 v16, s[32:35], s60 offen nt lds
  v_mfma_f32_16x16x32_bf16 v[164:167], v[204:207], v[236:239], v[164:167]
  buffer_load_dwordx4 v17, s[32:35], s60 offen offset:1024 nt lds
  v_mfma_f32_16x16x32_bf16 v[168:171], v[204:207], v[240:243], v[168:171]
  buffer_load_dwordx4 v18, s[32:35], s60 offen offset:2048 nt lds
  v_mfma_f32_16x16x32_bf16 v[172:175], v[204:207], v[244:247], v[172:175]
  buffer_load_dwordx4 v19, s[32:35], s60 offen offset:3072 nt lds
  s_waitcnt lgkmcnt(0)
  v_mfma_f32_16x16x32_bf16 v[96:99], v[176:179], v[208:211], v[96:99]
  s_waitcnt vmcnt(8)
  v_mfma_f32_16x16x32_bf16 v[100:103], v[176:179], v[212:215], v[100:103]
  ds_read_b64_tr_b16 v[192:193], v34 offset:12288
  ds_read_b64_tr_b16 v[194:195], v34 offset:12800
  v_mfma_f32_16x16x32_bf16 v[104:107], v[176:179], v[216:219], v[104:107]
  ds_read_b64_tr_b16 v[196:197], v35 offset:12288
  v_mfma_f32_16x16x32_bf16 v[108:111], v[176:179], v[220:223], v[108:111]
  ds_read_b64_tr_b16 v[198:199], v35 offset:12800
  ds_read_b64_tr_b16 v[200:201], v36 offset:12288
  v_mfma_f32_16x16x32_bf16 v[112:115], v[176:179], v[224:227], v[112:115]
  ds_read_b64_tr_b16 v[202:203], v36 offset:12800
  v_mfma_f32_16x16x32_bf16 v[116:119], v[180:183], v[208:211], v[116:119]
  ds_read_b64_tr_b16 v[204:205], v37 offset:12288
  v_mfma_f32_16x16x32_bf16 v[120:123], v[180:183], v[212:215], v[120:123]
  ds_read_b64_tr_b16 v[206:207], v37 offset:12800
  v_add_u32 v43, s74, v43
  v_mfma_f32_16x16x32_bf16 v[124:127], v[180:183], v[216:219], v[124:127]
  v_add_u32 v47, s74, v47
  v_mfma_f32_16x16x32_bf16 v[128:131], v[180:183], v[220:223], v[128:131]
  v_add_u32 v51, s74, v51
  v_add_u32 v55, s74, v55
  v_mfma_f32_16x16x32_bf16 v[132:135], v[180:183], v[224:227], v[132:135]
  v_add_u32 v59, s74, v59
  v_mfma_f32_16x16x32_bf16 v[136:139], v[184:187], v[208:211], v[136:139]
  ds_read_b128 v[228:231], v43
  v_mfma_f32_16x16x32_bf16 v[140:143], v[184:187], v[212:215], v[140:143]
  ds_read_b128 v[232:235], v47
  ds_read_b128 v[236:239], v51
  v_mfma_f32_16x16x32_bf16 v[144:147], v[184:187], v[216:219], v[144:147]
  ds_read_b128 v[240:243], v55
  v_mfma_f32_16x16x32_bf16 v[148:151], v[184:187], v[220:223], v[148:151]
  ds_read_b128 v[244:247], v59
  v_mfma_f32_16x16x32_bf16 v[152:155], v[184:187], v[224:227], v[152:155]
  v_mfma_f32_16x16x32_bf16 v[156:159], v[188:191], v[208:211], v[156:159]
  v_mfma_f32_16x16x32_bf16 v[160:163], v[188:191], v[212:215], v[160:163]
  v_mfma_f32_16x16x32_bf16 v[164:167], v[188:191], v[216:219], v[164:167]
  v_mfma_f32_16x16x32_bf16 v[168:171], v[188:191], v[220:223], v[168:171]
  v_mfma_f32_16x16x32_bf16 v[172:175], v[188:191], v[224:227], v[172:175]
  s_waitcnt lgkmcnt(0)
  v_mfma_f32_16x16x32_bf16 v[96:99], v[192:195], v[228:231], v[96:99]
  v_mfma_f32_16x16x32_bf16 v[100:103], v[192:195], v[232:235], v[100:103]
  v_mfma_f32_16x16x32_bf16 v[104:107], v[192:195], v[236:239], v[104:107]
  v_mfma_f32_16x16x32_bf16 v[108:111], v[192:195], v[240:243], v[108:111]
  v_mfma_f32_16x16x32_bf16 v[112:115], v[192:195], v[244:247], v[112:115]
  v_mfma_f32_16x16x32_bf16 v[116:119], v[196:199], v[228:231], v[116:119]
  v_mfma_f32_16x16x32_bf16 v[120:123], v[196:199], v[232:235], v[120:123]
  v_mfma_f32_16x16x32_bf16 v[124:127], v[196:199], v[236:239], v[124:127]
  v_mfma_f32_16x16x32_bf16 v[128:131], v[196:199], v[240:243], v[128:131]
  s_add_u32 s61, s52, 8192
  s_mov_b32 m0, s61
  v_mfma_f32_16x16x32_bf16 v[132:135], v[196:199], v[244:247], v[132:135]
  s_add_u32 s60, s62, 4096
  v_mfma_f32_16x16x32_bf16 v[136:139], v[200:203], v[228:231], v[136:139]
  buffer_load_dwordx4 v20, s[36:39], s62 offen nt lds
  v_mfma_f32_16x16x32_bf16 v[140:143], v[200:203], v[232:235], v[140:143]
  buffer_load_dwordx4 v21, s[36:39], s62 offen offset:1024 nt lds
  v_mfma_f32_16x16x32_bf16 v[144:147], v[200:203], v[236:239], v[144:147]
  buffer_load_dwordx4 v20, s[36:39], s62 offen offset:2048 nt lds
  v_mfma_f32_16x16x32_bf16 v[148:151], v[200:203], v[240:243], v[148:151]
  buffer_load_dwordx4 v21, s[36:39], s62 offen offset:3072 nt lds
  v_mfma_f32_16x16x32_bf16 v[152:155], v[200:203], v[244:247], v[152:155]
  s_add_u32 m0, m0, 4096
  v_mfma_f32_16x16x32_bf16 v[156:159], v[204:207], v[228:231], v[156:159]
  s_nop 0
  v_mfma_f32_16x16x32_bf16 v[160:163], v[204:207], v[232:235], v[160:163]
  buffer_load_dwordx4 v20, s[36:39], s60 offen nt lds
  v_mfma_f32_16x16x32_bf16 v[164:167], v[204:207], v[236:239], v[164:167]
  buffer_load_dwordx4 v21, s[36:39], s60 offen offset:1024 nt lds
  v_mfma_f32_16x16x32_bf16 v[168:171], v[204:207], v[240:243], v[168:171]
  buffer_load_dwordx4 v20, s[36:39], s60 offen offset:2048 nt lds
  v_mfma_f32_16x16x32_bf16 v[172:175], v[204:207], v[244:247], v[172:175]
  buffer_load_dwordx4 v21, s[36:39], s60 offen offset:3072 nt lds
  s_nop 7
  s_lshl_b32 s59, s31, 1
  s_mul_i32 s59, s59, 40960
  s_add_u32 s59, s59, 16384
  s_lshl_b32 s60, s27, 9
  s_add_u32 s60, s60, s59
  v_lshrrev_b32 v28, 1, v22
  v_lshlrev_b32 v28, 10, v28
  v_lshlrev_b32 v29, 4, v23
  v_add_u32 v28, v28, v29
  v_and_b32 v29, 1, v22
  v_lshlrev_b32 v29, 3, v29
  v_add_u32 v28, v28, v29
  v_add_u32 v28, s60, v28
  v_add_u32 v29, s59, v2
  s_barrier
  v_pk_mul_f32 v[96:97], v[96:97], s[66:67]
  v_pk_mul_f32 v[98:99], v[98:99], s[66:67]
  v_cvt_pk_bf16_f32 v96, v96, v97
  v_cvt_pk_bf16_f32 v97, v98, v99
  ds_write_b64 v28, v[96:97] offset:0
  v_pk_mul_f32 v[100:101], v[100:101], s[66:67]
  v_pk_mul_f32 v[102:103], v[102:103], s[66:67]
  v_cvt_pk_bf16_f32 v100, v100, v101
  v_cvt_pk_bf16_f32 v101, v102, v103
  ds_write_b64 v28, v[100:101] offset:4096
  v_pk_mul_f32 v[104:105], v[104:105], s[66:67]
  v_pk_mul_f32 v[106:107], v[106:107], s[66:67]
  v_cvt_pk_bf16_f32 v104, v104, v105
  v_cvt_pk_bf16_f32 v105, v106, v107
  ds_write_b64 v28, v[104:105] offset:8192
  v_pk_mul_f32 v[108:109], v[108:109], s[66:67]
  v_pk_mul_f32 v[110:111], v[110:111], s[66:67]
  v_cvt_pk_bf16_f32 v108, v108, v109
  v_cvt_pk_bf16_f32 v109, v110, v111
  ds_write_b64 v28, v[108:109] offset:12288
  v_pk_mul_f32 v[112:113], v[112:113], s[66:67]
  v_pk_mul_f32 v[114:115], v[114:115], s[66:67]
  v_cvt_pk_bf16_f32 v112, v112, v113
  v_cvt_pk_bf16_f32 v113, v114, v115
  ds_write_b64 v28, v[112:113] offset:16384
  v_pk_mul_f32 v[116:117], v[116:117], s[66:67]
  v_pk_mul_f32 v[118:119], v[118:119], s[66:67]
  v_cvt_pk_bf16_f32 v116, v116, v117
  v_cvt_pk_bf16_f32 v117, v118, v119
  ds_write_b64 v28, v[116:117] offset:2048
  v_pk_mul_f32 v[120:121], v[120:121], s[66:67]
  v_pk_mul_f32 v[122:123], v[122:123], s[66:67]
  v_cvt_pk_bf16_f32 v120, v120, v121
  v_cvt_pk_bf16_f32 v121, v122, v123
  ds_write_b64 v28, v[120:121] offset:6144
  v_pk_mul_f32 v[124:125], v[124:125], s[66:67]
  v_pk_mul_f32 v[126:127], v[126:127], s[66:67]
  v_cvt_pk_bf16_f32 v124, v124, v125
  v_cvt_pk_bf16_f32 v125, v126, v127
  ds_write_b64 v28, v[124:125] offset:10240
  v_pk_mul_f32 v[128:129], v[128:129], s[66:67]
  v_pk_mul_f32 v[130:131], v[130:131], s[66:67]
  v_cvt_pk_bf16_f32 v128, v128, v129
  v_cvt_pk_bf16_f32 v129, v130, v131
  ds_write_b64 v28, v[128:129] offset:14336
  v_pk_mul_f32 v[132:133], v[132:133], s[66:67]
  v_pk_mul_f32 v[134:135], v[134:135], s[66:67]
  v_cvt_pk_bf16_f32 v132, v132, v133
  v_cvt_pk_bf16_f32 v133, v134, v135
  ds_write_b64 v28, v[132:133] offset:18432
  v_pk_mul_f32 v[136:137], v[136:137], s[66:67]
  v_pk_mul_f32 v[138:139], v[138:139], s[66:67]
  v_cvt_pk_bf16_f32 v136, v136, v137
  v_cvt_pk_bf16_f32 v137, v138, v139
  ds_write_b64 v28, v[136:137] offset:256
  v_pk_mul_f32 v[140:141], v[140:141], s[66:67]
  v_pk_mul_f32 v[142:143], v[142:143], s[66:67]
  v_cvt_pk_bf16_f32 v140, v140, v141
  v_cvt_pk_bf16_f32 v141, v142, v143
  ds_write_b64 v28, v[140:141] offset:4352
  v_pk_mul_f32 v[144:145], v[144:145], s[66:67]
  v_pk_mul_f32 v[146:147], v[146:147], s[66:67]
  v_cvt_pk_bf16_f32 v144, v144, v145
  v_cvt_pk_bf16_f32 v145, v146, v147
  ds_write_b64 v28, v[144:145] offset:8448
  v_pk_mul_f32 v[148:149], v[148:149], s[66:67]
  v_pk_mul_f32 v[150:151], v[150:151], s[66:67]
  v_cvt_pk_bf16_f32 v148, v148, v149
  v_cvt_pk_bf16_f32 v149, v150, v151
  ds_write_b64 v28, v[148:149] offset:12544
  v_pk_mul_f32 v[152:153], v[152:153], s[66:67]
  v_pk_mul_f32 v[154:155], v[154:155], s[66:67]
  v_cvt_pk_bf16_f32 v152, v152, v153
  v_cvt_pk_bf16_f32 v153, v154, v155
  ds_write_b64 v28, v[152:153] offset:16640
  v_pk_mul_f32 v[156:157], v[156:157], s[66:67]
  v_pk_mul_f32 v[158:159], v[158:159], s[66:67]
  v_cvt_pk_bf16_f32 v156, v156, v157
  v_cvt_pk_bf16_f32 v157, v158, v159
  ds_write_b64 v28, v[156:157] offset:2304
  v_pk_mul_f32 v[160:161], v[160:161], s[66:67]
  v_pk_mul_f32 v[162:163], v[162:163], s[66:67]
  v_cvt_pk_bf16_f32 v160, v160, v161
  v_cvt_pk_bf16_f32 v161, v162, v163
  ds_write_b64 v28, v[160:161] offset:6400
  v_pk_mul_f32 v[164:165], v[164:165], s[66:67]
  v_pk_mul_f32 v[166:167], v[166:167], s[66:67]
  v_cvt_pk_bf16_f32 v164, v164, v165
  v_cvt_pk_bf16_f32 v165, v166, v167
  ds_write_b64 v28, v[164:165] offset:10496
  v_pk_mul_f32 v[168:169], v[168:169], s[66:67]
  v_pk_mul_f32 v[170:171], v[170:171], s[66:67]
  v_cvt_pk_bf16_f32 v168, v168, v169
  v_cvt_pk_bf16_f32 v169, v170, v171
  ds_write_b64 v28, v[168:169] offset:14592
  v_pk_mul_f32 v[172:173], v[172:173], s[66:67]
  v_pk_mul_f32 v[174:175], v[174:175], s[66:67]
  v_cvt_pk_bf16_f32 v172, v172, v173
  v_cvt_pk_bf16_f32 v173, v174, v175
  ds_write_b64 v28, v[172:173] offset:18688
  s_waitcnt lgkmcnt(0)
  s_barrier
  ds_read_b128 a[160:163], v29 offset:0
  ds_read_b128 a[164:167], v29 offset:1024
  ds_read_b128 a[168:171], v29 offset:2048
  ds_read_b128 a[172:175], v29 offset:3072
  ds_read_b128 a[176:179], v29 offset:4096
  ds_read_b128 a[180:183], v29 offset:5120
  ds_read_b128 a[184:187], v29 offset:6144
  ds_read_b128 a[188:191], v29 offset:7168
  ds_read_b128 a[192:195], v29 offset:8192
  ds_read_b128 a[196:199], v29 offset:9216
  ds_read_b128 a[200:203], v29 offset:10240
  ds_read_b128 a[204:207], v29 offset:11264
  ds_read_b128 a[208:211], v29 offset:12288
  ds_read_b128 a[212:215], v29 offset:13312
  ds_read_b128 a[216:219], v29 offset:14336
  ds_read_b128 a[220:223], v29 offset:15360
  ds_read_b128 a[224:227], v29 offset:16384
  ds_read_b128 a[228:231], v29 offset:17408
  ds_read_b128 a[232:235], v29 offset:18432
  ds_read_b128 a[236:239], v29 offset:19456
concat_heads__gqa_block_cached__mha_block_cached__near_ridge_kernel_restart:
  v_mov_b32 v196, 0x3f803f80
  v_mov_b32 v197, 0x3f803f80
  v_mov_b32 v198, 0x3f803f80
  v_mov_b32 v199, 0x3f803f80
  v_mov_b32 v112, 0
  v_mov_b32 v113, 0
  v_mov_b32 v114, 0
  v_mov_b32 v115, 0
  v_mov_b32 v116, 0
  v_mov_b32 v117, 0
  v_mov_b32 v118, 0
  v_mov_b32 v119, 0
  v_mov_b32 v120, 0
  v_mov_b32 v121, 0
  v_mov_b32 v122, 0
  v_mov_b32 v123, 0
  v_mov_b32 v124, 0
  v_mov_b32 v125, 0
  v_mov_b32 v126, 0
  v_mov_b32 v127, 0
  v_mov_b32 v128, 0
  v_mov_b32 v129, 0
  v_mov_b32 v130, 0
  v_mov_b32 v131, 0
  s_mov_b32 s53, 0
  s_mov_b32 s54, 8192
  s_add_u32 s57, s70, 32768
  s_add_u32 s58, s70, 16384
  s_and_b32 s57, s57, 524287
  s_and_b32 s58, s58, 524287
  s_waitcnt lgkmcnt(0)
  s_barrier
  s_cmp_lg_u32 s28, 0
  s_cbranch_scc1 concat_heads__gqa_block_cached__mha_block_cached__near_ridge_kernel_bpath
  s_mov_b32 s34, s17
  s_mov_b32 s38, s17
  s_lshl_b32 s62, s31, 12
  s_add_u32 s57, s62, s70
  s_add_u32 s58, s62, s70
  s_waitcnt vmcnt(0)
  s_barrier
  s_add_u32 s61, s65, 0
  s_mov_b32 m0, s61
  s_nop 0
  buffer_load_dwordx4 v16, s[32:35], s57 offen nt lds
  buffer_load_dwordx4 v17, s[32:35], s57 offen offset:1024 nt lds
  buffer_load_dwordx4 v18, s[32:35], s57 offen offset:2048 nt lds
  buffer_load_dwordx4 v19, s[32:35], s57 offen offset:3072 nt lds
  s_add_u32 s57, s57, 16384
  s_add_u32 s61, s65, 8192
  s_mov_b32 m0, s61
  s_nop 0
  buffer_load_dwordx4 v20, s[36:39], s58 offen nt lds
  buffer_load_dwordx4 v21, s[36:39], s58 offen offset:1024 nt lds
  buffer_load_dwordx4 v20, s[36:39], s58 offen offset:2048 nt lds
  buffer_load_dwordx4 v21, s[36:39], s58 offen offset:3072 nt lds
  s_add_u32 s58, s58, 16384
  s_add_u32 s74, s65, 8192
  s_waitcnt vmcnt(4)
  s_barrier
  ds_read_b128 v[132:135], v4
  ds_read_b128 v[136:139], v5
  ds_read_b128 v[140:143], v6
  ds_read_b128 v[144:147], v7
  ds_read_b128 v[148:151], v4 offset:4096
  ds_read_b128 v[152:155], v5 offset:4096
  ds_read_b128 v[156:159], v6 offset:4096
  ds_read_b128 v[160:163], v7 offset:4096
  s_waitcnt lgkmcnt(0)
  s_cmp_lg_u32 s16, 0
  s_cbranch_scc1 concat_heads__gqa_block_cached__mha_block_cached__near_ridge_kernel_havemaxA
  v_mfma_f32_16x16x32_bf16 v[32:35], v[132:135], a[160:163], 0
  v_mfma_f32_16x16x32_bf16 v[32:35], v[136:139], a[164:167], v[32:35]
  v_mfma_f32_16x16x32_bf16 v[32:35], v[140:143], a[168:171], v[32:35]
  v_mfma_f32_16x16x32_bf16 v[32:35], v[144:147], a[172:175], v[32:35]
  v_mfma_f32_16x16x32_bf16 v[36:39], v[148:151], a[160:163], 0
  v_mfma_f32_16x16x32_bf16 v[36:39], v[152:155], a[164:167], v[36:39]
  v_mfma_f32_16x16x32_bf16 v[36:39], v[156:159], a[168:171], v[36:39]
  v_mfma_f32_16x16x32_bf16 v[36:39], v[160:163], a[172:175], v[36:39]
  v_mfma_f32_16x16x32_bf16 v[40:43], v[132:135], a[176:179], 0
  v_mfma_f32_16x16x32_bf16 v[40:43], v[136:139], a[180:183], v[40:43]
  v_mfma_f32_16x16x32_bf16 v[40:43], v[140:143], a[184:187], v[40:43]
  v_mfma_f32_16x16x32_bf16 v[40:43], v[144:147], a[188:191], v[40:43]
  v_mfma_f32_16x16x32_bf16 v[44:47], v[148:151], a[176:179], 0
  v_mfma_f32_16x16x32_bf16 v[44:47], v[152:155], a[180:183], v[44:47]
  v_mfma_f32_16x16x32_bf16 v[44:47], v[156:159], a[184:187], v[44:47]
  v_mfma_f32_16x16x32_bf16 v[44:47], v[160:163], a[188:191], v[44:47]
  v_mfma_f32_16x16x32_bf16 v[48:51], v[132:135], a[192:195], 0
  v_mfma_f32_16x16x32_bf16 v[48:51], v[136:139], a[196:199], v[48:51]
  v_mfma_f32_16x16x32_bf16 v[48:51], v[140:143], a[200:203], v[48:51]
  v_mfma_f32_16x16x32_bf16 v[48:51], v[144:147], a[204:207], v[48:51]
  v_mfma_f32_16x16x32_bf16 v[52:55], v[148:151], a[192:195], 0
  v_mfma_f32_16x16x32_bf16 v[52:55], v[152:155], a[196:199], v[52:55]
  v_mfma_f32_16x16x32_bf16 v[52:55], v[156:159], a[200:203], v[52:55]
  v_mfma_f32_16x16x32_bf16 v[52:55], v[160:163], a[204:207], v[52:55]
  v_mfma_f32_16x16x32_bf16 v[56:59], v[132:135], a[208:211], 0
  v_mfma_f32_16x16x32_bf16 v[56:59], v[136:139], a[212:215], v[56:59]
  v_mfma_f32_16x16x32_bf16 v[56:59], v[140:143], a[216:219], v[56:59]
  v_mfma_f32_16x16x32_bf16 v[56:59], v[144:147], a[220:223], v[56:59]
  v_mfma_f32_16x16x32_bf16 v[60:63], v[148:151], a[208:211], 0
  v_mfma_f32_16x16x32_bf16 v[60:63], v[152:155], a[212:215], v[60:63]
  v_mfma_f32_16x16x32_bf16 v[60:63], v[156:159], a[216:219], v[60:63]
  v_mfma_f32_16x16x32_bf16 v[60:63], v[160:163], a[220:223], v[60:63]
  v_mfma_f32_16x16x32_bf16 v[64:67], v[132:135], a[224:227], 0
  v_mfma_f32_16x16x32_bf16 v[64:67], v[136:139], a[228:231], v[64:67]
  v_mfma_f32_16x16x32_bf16 v[64:67], v[140:143], a[232:235], v[64:67]
  v_mfma_f32_16x16x32_bf16 v[64:67], v[144:147], a[236:239], v[64:67]
  v_mfma_f32_16x16x32_bf16 v[68:71], v[148:151], a[224:227], 0
  v_mfma_f32_16x16x32_bf16 v[68:71], v[152:155], a[228:231], v[68:71]
  v_mfma_f32_16x16x32_bf16 v[68:71], v[156:159], a[232:235], v[68:71]
  v_mfma_f32_16x16x32_bf16 v[68:71], v[160:163], a[236:239], v[68:71]
  s_nop 7
  v_xor_b32 v22, 16, v1
  v_lshlrev_b32 v22, 2, v22
  v_xor_b32 v23, 32, v1
  v_lshlrev_b32 v23, 2, v23
  v_max3_f32 v32, v32, v33, v34
  v_max3_f32 v35, v35, v36, v37
  v_max3_f32 v32, v32, v38, v39
  v_max_f32 v32, v32, v35
  v_max3_f32 v40, v40, v41, v42
  v_max3_f32 v43, v43, v44, v45
  v_max3_f32 v40, v40, v46, v47
  v_max_f32 v40, v40, v43
  v_max3_f32 v48, v48, v49, v50
  v_max3_f32 v51, v51, v52, v53
  v_max3_f32 v48, v48, v54, v55
  v_max_f32 v48, v48, v51
  v_max3_f32 v56, v56, v57, v58
  v_max3_f32 v59, v59, v60, v61
  v_max3_f32 v56, v56, v62, v63
  v_max_f32 v56, v56, v59
  v_max3_f32 v64, v64, v65, v66
  v_max3_f32 v67, v67, v68, v69
  v_max3_f32 v64, v64, v70, v71
  v_max_f32 v64, v64, v67
  ds_bpermute_b32 v33, v22, v32
  ds_bpermute_b32 v41, v22, v40
  ds_bpermute_b32 v49, v22, v48
  ds_bpermute_b32 v57, v22, v56
  ds_bpermute_b32 v65, v22, v64
  s_waitcnt lgkmcnt(0)
  v_max_f32 v32, v32, v33
  v_max_f32 v40, v40, v41
  v_max_f32 v48, v48, v49
  v_max_f32 v56, v56, v57
  v_max_f32 v64, v64, v65
  ds_bpermute_b32 v33, v23, v32
  ds_bpermute_b32 v41, v23, v40
  ds_bpermute_b32 v49, v23, v48
  ds_bpermute_b32 v57, v23, v56
  ds_bpermute_b32 v65, v23, v64
  s_waitcnt lgkmcnt(0)
  v_max_f32 v32, v32, v33
  v_sub_f32 v92, 0, v32
  v_sub_f32 v93, 0, v32
  v_sub_f32 v94, 0, v32
  v_sub_f32 v95, 0, v32
  v_max_f32 v40, v40, v41
  v_sub_f32 v96, 0, v40
  v_sub_f32 v97, 0, v40
  v_sub_f32 v98, 0, v40
  v_sub_f32 v99, 0, v40
  v_max_f32 v48, v48, v49
  v_sub_f32 v100, 0, v48
  v_sub_f32 v101, 0, v48
  v_sub_f32 v102, 0, v48
  v_sub_f32 v103, 0, v48
  v_max_f32 v56, v56, v57
  v_sub_f32 v104, 0, v56
  v_sub_f32 v105, 0, v56
  v_sub_f32 v106, 0, v56
  v_sub_f32 v107, 0, v56
  v_max_f32 v64, v64, v65
  v_sub_f32 v108, 0, v64
  v_sub_f32 v109, 0, v64
  v_sub_f32 v110, 0, v64
  v_sub_f32 v111, 0, v64
concat_heads__gqa_block_cached__mha_block_cached__near_ridge_kernel_havemaxA:
  s_nop 1
  v_mfma_f32_16x16x32_bf16 v[32:35], v[132:135], a[160:163], v[92:95]
  v_accvgpr_write_b32 a12, 0
  v_accvgpr_write_b32 a13, 0
  v_accvgpr_write_b32 a14, 0
  v_accvgpr_write_b32 a15, 0
  v_mfma_f32_16x16x32_bf16 v[32:35], v[136:139], a[164:167], v[32:35]
  v_accvgpr_write_b32 a32, 0
  v_accvgpr_write_b32 a33, 0
  v_accvgpr_write_b32 a34, 0
  v_accvgpr_write_b32 a35, 0
  v_mfma_f32_16x16x32_bf16 v[32:35], v[140:143], a[168:171], v[32:35]
  v_accvgpr_write_b32 a52, 0
  v_accvgpr_write_b32 a53, 0
  v_accvgpr_write_b32 a54, 0
  v_accvgpr_write_b32 a55, 0
  v_mfma_f32_16x16x32_bf16 v[32:35], v[144:147], a[172:175], v[32:35]
  v_accvgpr_write_b32 a72, 0
  v_accvgpr_write_b32 a73, 0
  v_accvgpr_write_b32 a74, 0
  v_accvgpr_write_b32 a75, 0
  v_mfma_f32_16x16x32_bf16 v[36:39], v[148:151], a[160:163], v[92:95]
  v_accvgpr_write_b32 a92, 0
  v_accvgpr_write_b32 a93, 0
  v_accvgpr_write_b32 a94, 0
  v_accvgpr_write_b32 a95, 0
  v_mfma_f32_16x16x32_bf16 v[36:39], v[152:155], a[164:167], v[36:39]
  v_accvgpr_write_b32 a112, 0
  v_accvgpr_write_b32 a113, 0
  v_accvgpr_write_b32 a114, 0
  v_accvgpr_write_b32 a115, 0
  v_mfma_f32_16x16x32_bf16 v[36:39], v[156:159], a[168:171], v[36:39]
  v_accvgpr_write_b32 a132, 0
  v_accvgpr_write_b32 a133, 0
  v_accvgpr_write_b32 a134, 0
  v_accvgpr_write_b32 a135, 0
  v_mfma_f32_16x16x32_bf16 v[36:39], v[160:163], a[172:175], v[36:39]
  v_accvgpr_write_b32 a152, 0
  v_accvgpr_write_b32 a153, 0
  v_accvgpr_write_b32 a154, 0
  v_accvgpr_write_b32 a155, 0
  s_waitcnt vmcnt(0)
  s_barrier
  v_mfma_f32_16x16x32_bf16 v[40:43], v[132:135], a[176:179], v[96:99]
  ds_read_b64_tr_b16 v[164:165], v8
  ds_read_b64_tr_b16 v[166:167], v8 offset:4096
  v_accvgpr_write_b32 a16, 0
  v_accvgpr_write_b32 a17, 0
  v_accvgpr_write_b32 a18, 0
  v_accvgpr_write_b32 a19, 0
  v_mfma_f32_16x16x32_bf16 v[40:43], v[136:139], a[180:183], v[40:43]
  ds_read_b64_tr_b16 v[168:169], v9
  ds_read_b64_tr_b16 v[170:171], v9 offset:4096
  v_accvgpr_write_b32 a36, 0
  v_accvgpr_write_b32 a37, 0
  v_accvgpr_write_b32 a38, 0
  v_accvgpr_write_b32 a39, 0
  s_mov_b32 m0, s65
  s_nop 0
  v_mfma_f32_16x16x32_bf16 v[40:43], v[140:143], a[184:187], v[40:43]
  ds_read_b64_tr_b16 v[172:173], v10
  ds_read_b64_tr_b16 v[174:175], v10 offset:4096
  v_accvgpr_write_b32 a56, 0
  v_accvgpr_write_b32 a57, 0
  v_accvgpr_write_b32 a58, 0
  v_accvgpr_write_b32 a59, 0
  buffer_load_dwordx4 v16, s[32:35], s57 offen nt lds
  v_mfma_f32_16x16x32_bf16 v[40:43], v[144:147], a[188:191], v[40:43]
  ds_read_b64_tr_b16 v[176:177], v11
  ds_read_b64_tr_b16 v[178:179], v11 offset:4096
  v_accvgpr_write_b32 a76, 0
  v_accvgpr_write_b32 a77, 0
  v_accvgpr_write_b32 a78, 0
  v_accvgpr_write_b32 a79, 0
  buffer_load_dwordx4 v17, s[32:35], s57 offen offset:1024 nt lds
  v_mfma_f32_16x16x32_bf16 v[44:47], v[148:151], a[176:179], v[96:99]
  ds_read_b64_tr_b16 v[180:181], v12
  ds_read_b64_tr_b16 v[182:183], v12 offset:4096
  v_accvgpr_write_b32 a96, 0
  v_accvgpr_write_b32 a97, 0
  v_accvgpr_write_b32 a98, 0
  v_accvgpr_write_b32 a99, 0
  buffer_load_dwordx4 v18, s[32:35], s57 offen offset:2048 nt lds
  v_mfma_f32_16x16x32_bf16 v[44:47], v[152:155], a[180:183], v[44:47]
  ds_read_b64_tr_b16 v[184:185], v13
  ds_read_b64_tr_b16 v[186:187], v13 offset:4096
  v_accvgpr_write_b32 a116, 0
  v_accvgpr_write_b32 a117, 0
  v_accvgpr_write_b32 a118, 0
  v_accvgpr_write_b32 a119, 0
  buffer_load_dwordx4 v19, s[32:35], s57 offen offset:3072 nt lds
  v_mfma_f32_16x16x32_bf16 v[44:47], v[156:159], a[184:187], v[44:47]
  ds_read_b64_tr_b16 v[188:189], v14
  ds_read_b64_tr_b16 v[190:191], v14 offset:4096
  v_accvgpr_write_b32 a136, 0
  v_accvgpr_write_b32 a137, 0
  v_accvgpr_write_b32 a138, 0
  v_accvgpr_write_b32 a139, 0
  s_add_u32 s57, s57, 16384
  v_mfma_f32_16x16x32_bf16 v[44:47], v[160:163], a[188:191], v[44:47]
  ds_read_b64_tr_b16 v[192:193], v15
  ds_read_b64_tr_b16 v[194:195], v15 offset:4096
  v_accvgpr_write_b32 a156, 0
  v_accvgpr_write_b32 a157, 0
  v_accvgpr_write_b32 a158, 0
  v_accvgpr_write_b32 a159, 0
  v_exp_f32 v32, v32
  v_exp_f32 v33, v33
  v_exp_f32 v34, v34
  v_cvt_pk_bf16_f32 v72, v32, v33
  v_exp_f32 v35, v35
  v_exp_f32 v36, v36
  v_cvt_pk_bf16_f32 v73, v34, v35
  v_exp_f32 v37, v37
  v_exp_f32 v38, v38
  v_cvt_pk_bf16_f32 v74, v36, v37
  v_exp_f32 v39, v39
  s_nop 0
  v_cvt_pk_bf16_f32 v75, v38, v39
  v_mfma_f32_16x16x32_bf16 v[48:51], v[132:135], a[192:195], v[100:103]
  v_mfma_f32_16x16x32_bf16 v[48:51], v[136:139], a[196:199], v[48:51]
  v_mfma_f32_16x16x32_bf16 v[48:51], v[140:143], a[200:203], v[48:51]
  v_exp_f32 v40, v40
  v_mfma_f32_16x16x32_bf16 v[48:51], v[144:147], a[204:207], v[48:51]
  v_exp_f32 v41, v41
  v_mfma_f32_16x16x32_bf16 v[52:55], v[148:151], a[192:195], v[100:103]
  v_exp_f32 v42, v42
  v_mfma_f32_16x16x32_bf16 v[52:55], v[152:155], a[196:199], v[52:55]
  v_cvt_pk_bf16_f32 v76, v40, v41
  v_mfma_f32_16x16x32_bf16 v[52:55], v[156:159], a[200:203], v[52:55]
  v_exp_f32 v43, v43
  v_mfma_f32_16x16x32_bf16 v[52:55], v[160:163], a[204:207], v[52:55]
  v_exp_f32 v44, v44
  s_waitcnt lgkmcnt(0)
  v_mfma_f32_16x16x32_bf16 a[0:3], v[164:167], v[72:75], 0
  v_cvt_pk_bf16_f32 v77, v42, v43
  v_mfma_f32_16x16x32_bf16 a[20:23], v[168:171], v[72:75], 0
  v_exp_f32 v45, v45
  v_mfma_f32_16x16x32_bf16 a[40:43], v[172:175], v[72:75], 0
  v_exp_f32 v46, v46
  v_mfma_f32_16x16x32_bf16 a[60:63], v[176:179], v[72:75], 0
  v_cvt_pk_bf16_f32 v78, v44, v45
  v_mfma_f32_16x16x32_bf16 a[80:83], v[180:183], v[72:75], 0
  v_exp_f32 v47, v47
  s_barrier
  s_mov_b32 m0, s74
  v_mfma_f32_16x16x32_bf16 a[100:103], v[184:187], v[72:75], 0
  v_cvt_pk_bf16_f32 v79, v46, v47
  s_nop 0
  buffer_load_dwordx4 v20, s[36:39], s58 offen nt lds
  v_mfma_f32_16x16x32_bf16 a[120:123], v[188:191], v[72:75], 0
  buffer_load_dwordx4 v21, s[36:39], s58 offen offset:1024 nt lds
  v_mfma_f32_16x16x32_bf16 a[140:143], v[192:195], v[72:75], 0
  buffer_load_dwordx4 v20, s[36:39], s58 offen offset:2048 nt lds
  buffer_load_dwordx4 v21, s[36:39], s58 offen offset:3072 nt lds
  v_mfma_f32_16x16x32_bf16 v[112:115], v[196:199], v[72:75], 0
  s_add_u32 s58, s58, 16384
  v_mfma_f32_16x16x32_bf16 v[56:59], v[132:135], a[208:211], v[104:107]
  v_exp_f32 v48, v48
  v_mfma_f32_16x16x32_bf16 v[56:59], v[136:139], a[212:215], v[56:59]
  v_exp_f32 v49, v49
  v_mfma_f32_16x16x32_bf16 v[56:59], v[140:143], a[216:219], v[56:59]
  v_exp_f32 v50, v50
  v_mfma_f32_16x16x32_bf16 v[56:59], v[144:147], a[220:223], v[56:59]
  v_cvt_pk_bf16_f32 v80, v48, v49
  v_mfma_f32_16x16x32_bf16 v[60:63], v[148:151], a[208:211], v[104:107]
  v_exp_f32 v51, v51
  v_mfma_f32_16x16x32_bf16 v[60:63], v[152:155], a[212:215], v[60:63]
  v_exp_f32 v52, v52
  v_mfma_f32_16x16x32_bf16 v[60:63], v[156:159], a[216:219], v[60:63]
  v_cvt_pk_bf16_f32 v81, v50, v51
  v_mfma_f32_16x16x32_bf16 v[60:63], v[160:163], a[220:223], v[60:63]
  v_exp_f32 v53, v53
  v_mfma_f32_16x16x32_bf16 a[4:7], v[164:167], v[76:79], 0
  v_exp_f32 v54, v54
  v_mfma_f32_16x16x32_bf16 a[24:27], v[168:171], v[76:79], 0
  v_cvt_pk_bf16_f32 v82, v52, v53
  v_mfma_f32_16x16x32_bf16 a[44:47], v[172:175], v[76:79], 0
  v_exp_f32 v55, v55
  v_mfma_f32_16x16x32_bf16 a[64:67], v[176:179], v[76:79], 0
  v_cvt_pk_bf16_f32 v83, v54, v55
  v_mfma_f32_16x16x32_bf16 a[84:87], v[180:183], v[76:79], 0
  v_mfma_f32_16x16x32_bf16 a[104:107], v[184:187], v[76:79], 0
  v_mfma_f32_16x16x32_bf16 a[124:127], v[188:191], v[76:79], 0
  v_mfma_f32_16x16x32_bf16 a[144:147], v[192:195], v[76:79], 0
  v_mfma_f32_16x16x32_bf16 v[116:119], v[196:199], v[76:79], 0
  v_mfma_f32_16x16x32_bf16 v[64:67], v[132:135], a[224:227], v[108:111]
  v_exp_f32 v56, v56
  v_mfma_f32_16x16x32_bf16 v[64:67], v[136:139], a[228:231], v[64:67]
  v_exp_f32 v57, v57
  v_mfma_f32_16x16x32_bf16 v[64:67], v[140:143], a[232:235], v[64:67]
  v_exp_f32 v58, v58
  v_mfma_f32_16x16x32_bf16 v[64:67], v[144:147], a[236:239], v[64:67]
  v_cvt_pk_bf16_f32 v84, v56, v57
  v_mfma_f32_16x16x32_bf16 v[68:71], v[148:151], a[224:227], v[108:111]
  v_exp_f32 v59, v59
  v_mfma_f32_16x16x32_bf16 v[68:71], v[152:155], a[228:231], v[68:71]
  v_exp_f32 v60, v60
  v_mfma_f32_16x16x32_bf16 v[68:71], v[156:159], a[232:235], v[68:71]
  v_cvt_pk_bf16_f32 v85, v58, v59
  v_mfma_f32_16x16x32_bf16 v[68:71], v[160:163], a[236:239], v[68:71]
  v_exp_f32 v61, v61
  s_waitcnt vmcnt(4)
  s_barrier
  ds_read_b128 v[132:135], v4
  ds_read_b128 v[136:139], v5
  v_mfma_f32_16x16x32_bf16 a[8:11], v[164:167], v[80:83], 0
  v_exp_f32 v62, v62
  ds_read_b128 v[140:143], v6
  ds_read_b128 v[144:147], v7
  v_mfma_f32_16x16x32_bf16 a[28:31], v[168:171], v[80:83], 0
  v_cvt_pk_bf16_f32 v86, v60, v61
  ds_read_b128 v[148:151], v4 offset:4096
  ds_read_b128 v[152:155], v5 offset:4096
  v_mfma_f32_16x16x32_bf16 a[48:51], v[172:175], v[80:83], 0
  v_exp_f32 v63, v63
  ds_read_b128 v[156:159], v6 offset:4096
  ds_read_b128 v[160:163], v7 offset:4096
  v_mfma_f32_16x16x32_bf16 a[68:71], v[176:179], v[80:83], 0
  v_cvt_pk_bf16_f32 v87, v62, v63
  v_mfma_f32_16x16x32_bf16 a[88:91], v[180:183], v[80:83], 0
  v_mfma_f32_16x16x32_bf16 a[108:111], v[184:187], v[80:83], 0
  v_mfma_f32_16x16x32_bf16 a[128:131], v[188:191], v[80:83], 0
  v_mfma_f32_16x16x32_bf16 a[148:151], v[192:195], v[80:83], 0
  v_mfma_f32_16x16x32_bf16 v[120:123], v[196:199], v[80:83], 0
  s_mov_b32 s63, 31
concat_heads__gqa_block_cached__mha_block_cached__near_ridge_kernel_loopA:
  v_mfma_f32_16x16x32_bf16 a[12:15], v[164:167], v[84:87], a[12:15]
  v_exp_f32 v64, v64
  v_exp_f32 v65, v65
  v_mfma_f32_16x16x32_bf16 a[32:35], v[168:171], v[84:87], a[32:35]
  v_exp_f32 v66, v66
  v_mfma_f32_16x16x32_bf16 a[52:55], v[172:175], v[84:87], a[52:55]
  v_cvt_pk_bf16_f32 v88, v64, v65
  v_mfma_f32_16x16x32_bf16 a[72:75], v[176:179], v[84:87], a[72:75]
  v_exp_f32 v67, v67
  v_exp_f32 v68, v68
  v_mfma_f32_16x16x32_bf16 a[92:95], v[180:183], v[84:87], a[92:95]
  v_cvt_pk_bf16_f32 v89, v66, v67
  v_mfma_f32_16x16x32_bf16 a[112:115], v[184:187], v[84:87], a[112:115]
  v_exp_f32 v69, v69
  v_mfma_f32_16x16x32_bf16 a[132:135], v[188:191], v[84:87], a[132:135]
  v_exp_f32 v70, v70
  v_cvt_pk_bf16_f32 v90, v68, v69
  v_mfma_f32_16x16x32_bf16 a[152:155], v[192:195], v[84:87], a[152:155]
  v_exp_f32 v71, v71
  v_mfma_f32_16x16x32_bf16 v[124:127], v[196:199], v[84:87], v[124:127]
  v_cvt_pk_bf16_f32 v91, v70, v71
  s_waitcnt lgkmcnt(0)
  v_mfma_f32_16x16x32_bf16 v[32:35], v[132:135], a[160:163], v[92:95]
  v_mfma_f32_16x16x32_bf16 v[32:35], v[136:139], a[164:167], v[32:35]
  v_mfma_f32_16x16x32_bf16 v[32:35], v[140:143], a[168:171], v[32:35]
  v_mfma_f32_16x16x32_bf16 v[32:35], v[144:147], a[172:175], v[32:35]
  v_mfma_f32_16x16x32_bf16 v[36:39], v[148:151], a[160:163], v[92:95]
  v_mfma_f32_16x16x32_bf16 v[36:39], v[152:155], a[164:167], v[36:39]
  v_mfma_f32_16x16x32_bf16 v[36:39], v[156:159], a[168:171], v[36:39]
  v_mfma_f32_16x16x32_bf16 v[36:39], v[160:163], a[172:175], v[36:39]
  s_waitcnt vmcnt(0)
  s_barrier
  v_mfma_f32_16x16x32_bf16 a[16:19], v[164:167], v[88:91], a[16:19]
  ds_read_b64_tr_b16 v[164:165], v8
  ds_read_b64_tr_b16 v[166:167], v8 offset:4096
  v_mfma_f32_16x16x32_bf16 a[36:39], v[168:171], v[88:91], a[36:39]
  ds_read_b64_tr_b16 v[168:169], v9
  ds_read_b64_tr_b16 v[170:171], v9 offset:4096
  s_mov_b32 m0, s65
  s_nop 0
  v_mfma_f32_16x16x32_bf16 a[56:59], v[172:175], v[88:91], a[56:59]
  ds_read_b64_tr_b16 v[172:173], v10
  ds_read_b64_tr_b16 v[174:175], v10 offset:4096
  buffer_load_dwordx4 v16, s[32:35], s57 offen nt lds
  v_mfma_f32_16x16x32_bf16 a[76:79], v[176:179], v[88:91], a[76:79]
  ds_read_b64_tr_b16 v[176:177], v11
  ds_read_b64_tr_b16 v[178:179], v11 offset:4096
  v_exp_f32 v32, v32
  buffer_load_dwordx4 v17, s[32:35], s57 offen offset:1024 nt lds
  v_mfma_f32_16x16x32_bf16 a[96:99], v[180:183], v[88:91], a[96:99]
  ds_read_b64_tr_b16 v[180:181], v12
  ds_read_b64_tr_b16 v[182:183], v12 offset:4096
  v_exp_f32 v33, v33
  buffer_load_dwordx4 v18, s[32:35], s57 offen offset:2048 nt lds
  v_mfma_f32_16x16x32_bf16 a[116:119], v[184:187], v[88:91], a[116:119]
  ds_read_b64_tr_b16 v[184:185], v13
  ds_read_b64_tr_b16 v[186:187], v13 offset:4096
  v_exp_f32 v34, v34
  buffer_load_dwordx4 v19, s[32:35], s57 offen offset:3072 nt lds
  v_mfma_f32_16x16x32_bf16 a[136:139], v[188:191], v[88:91], a[136:139]
  ds_read_b64_tr_b16 v[188:189], v14
  ds_read_b64_tr_b16 v[190:191], v14 offset:4096
  v_cvt_pk_bf16_f32 v72, v32, v33
  s_add_u32 s57, s57, 16384
  v_mfma_f32_16x16x32_bf16 a[156:159], v[192:195], v[88:91], a[156:159]
  ds_read_b64_tr_b16 v[192:193], v15
  ds_read_b64_tr_b16 v[194:195], v15 offset:4096
  v_exp_f32 v35, v35
  v_mfma_f32_16x16x32_bf16 v[128:131], v[196:199], v[88:91], v[128:131]
  v_exp_f32 v36, v36
  v_mfma_f32_16x16x32_bf16 v[40:43], v[132:135], a[176:179], v[96:99]
  v_mfma_f32_16x16x32_bf16 v[40:43], v[136:139], a[180:183], v[40:43]
  v_cvt_pk_bf16_f32 v73, v34, v35
  v_mfma_f32_16x16x32_bf16 v[40:43], v[140:143], a[184:187], v[40:43]
  v_exp_f32 v37, v37
  v_mfma_f32_16x16x32_bf16 v[40:43], v[144:147], a[188:191], v[40:43]
  v_exp_f32 v38, v38
  v_mfma_f32_16x16x32_bf16 v[44:47], v[148:151], a[176:179], v[96:99]
  v_cvt_pk_bf16_f32 v74, v36, v37
  v_mfma_f32_16x16x32_bf16 v[44:47], v[152:155], a[180:183], v[44:47]
  v_exp_f32 v39, v39
  v_mfma_f32_16x16x32_bf16 v[44:47], v[156:159], a[184:187], v[44:47]
  v_cvt_pk_bf16_f32 v75, v38, v39
  v_mfma_f32_16x16x32_bf16 v[44:47], v[160:163], a[188:191], v[44:47]
  v_mfma_f32_16x16x32_bf16 v[48:51], v[132:135], a[192:195], v[100:103]
  v_mfma_f32_16x16x32_bf16 v[48:51], v[136:139], a[196:199], v[48:51]
  v_mfma_f32_16x16x32_bf16 v[48:51], v[140:143], a[200:203], v[48:51]
  v_exp_f32 v40, v40
  v_mfma_f32_16x16x32_bf16 v[48:51], v[144:147], a[204:207], v[48:51]
  v_exp_f32 v41, v41
  v_mfma_f32_16x16x32_bf16 v[52:55], v[148:151], a[192:195], v[100:103]
  v_exp_f32 v42, v42
  v_mfma_f32_16x16x32_bf16 v[52:55], v[152:155], a[196:199], v[52:55]
  v_cvt_pk_bf16_f32 v76, v40, v41
  v_mfma_f32_16x16x32_bf16 v[52:55], v[156:159], a[200:203], v[52:55]
  v_exp_f32 v43, v43
  v_mfma_f32_16x16x32_bf16 v[52:55], v[160:163], a[204:207], v[52:55]
  v_exp_f32 v44, v44
  s_waitcnt lgkmcnt(0)
  v_mfma_f32_16x16x32_bf16 a[0:3], v[164:167], v[72:75], a[0:3]
  v_cvt_pk_bf16_f32 v77, v42, v43
  v_mfma_f32_16x16x32_bf16 a[20:23], v[168:171], v[72:75], a[20:23]
  v_exp_f32 v45, v45
  v_mfma_f32_16x16x32_bf16 a[40:43], v[172:175], v[72:75], a[40:43]
  v_exp_f32 v46, v46
  v_mfma_f32_16x16x32_bf16 a[60:63], v[176:179], v[72:75], a[60:63]
  v_cvt_pk_bf16_f32 v78, v44, v45
  v_mfma_f32_16x16x32_bf16 a[80:83], v[180:183], v[72:75], a[80:83]
  v_exp_f32 v47, v47
  s_barrier
  s_mov_b32 m0, s74
  v_mfma_f32_16x16x32_bf16 a[100:103], v[184:187], v[72:75], a[100:103]
  v_cvt_pk_bf16_f32 v79, v46, v47
  s_nop 0
  buffer_load_dwordx4 v20, s[36:39], s58 offen nt lds
  v_mfma_f32_16x16x32_bf16 a[120:123], v[188:191], v[72:75], a[120:123]
  buffer_load_dwordx4 v21, s[36:39], s58 offen offset:1024 nt lds
  v_mfma_f32_16x16x32_bf16 a[140:143], v[192:195], v[72:75], a[140:143]
  buffer_load_dwordx4 v20, s[36:39], s58 offen offset:2048 nt lds
  buffer_load_dwordx4 v21, s[36:39], s58 offen offset:3072 nt lds
  v_mfma_f32_16x16x32_bf16 v[112:115], v[196:199], v[72:75], v[112:115]
  s_add_u32 s58, s58, 16384
  v_mfma_f32_16x16x32_bf16 v[56:59], v[132:135], a[208:211], v[104:107]
  v_exp_f32 v48, v48
  v_mfma_f32_16x16x32_bf16 v[56:59], v[136:139], a[212:215], v[56:59]
  v_exp_f32 v49, v49
  v_mfma_f32_16x16x32_bf16 v[56:59], v[140:143], a[216:219], v[56:59]
  v_exp_f32 v50, v50
  v_mfma_f32_16x16x32_bf16 v[56:59], v[144:147], a[220:223], v[56:59]
  v_cvt_pk_bf16_f32 v80, v48, v49
  v_mfma_f32_16x16x32_bf16 v[60:63], v[148:151], a[208:211], v[104:107]
  v_exp_f32 v51, v51
  v_mfma_f32_16x16x32_bf16 v[60:63], v[152:155], a[212:215], v[60:63]
  v_exp_f32 v52, v52
  v_mfma_f32_16x16x32_bf16 v[60:63], v[156:159], a[216:219], v[60:63]
  v_cvt_pk_bf16_f32 v81, v50, v51
  v_mfma_f32_16x16x32_bf16 v[60:63], v[160:163], a[220:223], v[60:63]
  v_exp_f32 v53, v53
  v_mfma_f32_16x16x32_bf16 a[4:7], v[164:167], v[76:79], a[4:7]
  v_exp_f32 v54, v54
  v_mfma_f32_16x16x32_bf16 a[24:27], v[168:171], v[76:79], a[24:27]
  v_cvt_pk_bf16_f32 v82, v52, v53
  v_mfma_f32_16x16x32_bf16 a[44:47], v[172:175], v[76:79], a[44:47]
  v_exp_f32 v55, v55
  v_mfma_f32_16x16x32_bf16 a[64:67], v[176:179], v[76:79], a[64:67]
  v_cvt_pk_bf16_f32 v83, v54, v55
  v_mfma_f32_16x16x32_bf16 a[84:87], v[180:183], v[76:79], a[84:87]
  v_mfma_f32_16x16x32_bf16 a[104:107], v[184:187], v[76:79], a[104:107]
  v_mfma_f32_16x16x32_bf16 a[124:127], v[188:191], v[76:79], a[124:127]
  v_mfma_f32_16x16x32_bf16 a[144:147], v[192:195], v[76:79], a[144:147]
  v_mfma_f32_16x16x32_bf16 v[116:119], v[196:199], v[76:79], v[116:119]
  v_mfma_f32_16x16x32_bf16 v[64:67], v[132:135], a[224:227], v[108:111]
  v_exp_f32 v56, v56
  v_mfma_f32_16x16x32_bf16 v[64:67], v[136:139], a[228:231], v[64:67]
  v_exp_f32 v57, v57
  v_mfma_f32_16x16x32_bf16 v[64:67], v[140:143], a[232:235], v[64:67]
  v_exp_f32 v58, v58
  v_mfma_f32_16x16x32_bf16 v[64:67], v[144:147], a[236:239], v[64:67]
  v_cvt_pk_bf16_f32 v84, v56, v57
  v_mfma_f32_16x16x32_bf16 v[68:71], v[148:151], a[224:227], v[108:111]
  v_exp_f32 v59, v59
  v_mfma_f32_16x16x32_bf16 v[68:71], v[152:155], a[228:231], v[68:71]
  v_exp_f32 v60, v60
  v_mfma_f32_16x16x32_bf16 v[68:71], v[156:159], a[232:235], v[68:71]
  v_cvt_pk_bf16_f32 v85, v58, v59
  v_mfma_f32_16x16x32_bf16 v[68:71], v[160:163], a[236:239], v[68:71]
  v_exp_f32 v61, v61
  s_waitcnt vmcnt(4)
  s_barrier
  ds_read_b128 v[132:135], v4
  ds_read_b128 v[136:139], v5
  v_mfma_f32_16x16x32_bf16 a[8:11], v[164:167], v[80:83], a[8:11]
  v_exp_f32 v62, v62
  ds_read_b128 v[140:143], v6
  ds_read_b128 v[144:147], v7
  v_mfma_f32_16x16x32_bf16 a[28:31], v[168:171], v[80:83], a[28:31]
  v_cvt_pk_bf16_f32 v86, v60, v61
  ds_read_b128 v[148:151], v4 offset:4096
  ds_read_b128 v[152:155], v5 offset:4096
  v_mfma_f32_16x16x32_bf16 a[48:51], v[172:175], v[80:83], a[48:51]
  v_exp_f32 v63, v63
  ds_read_b128 v[156:159], v6 offset:4096
  ds_read_b128 v[160:163], v7 offset:4096
  v_mfma_f32_16x16x32_bf16 a[68:71], v[176:179], v[80:83], a[68:71]
  v_cvt_pk_bf16_f32 v87, v62, v63
  v_mfma_f32_16x16x32_bf16 a[88:91], v[180:183], v[80:83], a[88:91]
  v_mfma_f32_16x16x32_bf16 a[108:111], v[184:187], v[80:83], a[108:111]
  v_mfma_f32_16x16x32_bf16 a[128:131], v[188:191], v[80:83], a[128:131]
  v_mfma_f32_16x16x32_bf16 a[148:151], v[192:195], v[80:83], a[148:151]
  v_mfma_f32_16x16x32_bf16 v[120:123], v[196:199], v[80:83], v[120:123]
  s_sub_u32 s63, s63, 1
  s_cmp_lg_u32 s63, 0
  s_cbranch_scc1 concat_heads__gqa_block_cached__mha_block_cached__near_ridge_kernel_loopA
  s_branch concat_heads__gqa_block_cached__mha_block_cached__near_ridge_kernel_tail
concat_heads__gqa_block_cached__mha_block_cached__near_ridge_kernel_bpath:
  s_cmp_eq_u32 s16, 0
  s_cbranch_scc1 concat_heads__gqa_block_cached__mha_block_cached__near_ridge_kernel_b01
  s_add_u32 s61, s52, 0
  s_mov_b32 s62, s70
  s_mov_b32 m0, s61
  s_add_u32 s60, s62, 4096
  buffer_load_dwordx4 v16, s[32:35], s62 offen nt lds
  buffer_load_dwordx4 v17, s[32:35], s62 offen offset:1024 nt lds
  buffer_load_dwordx4 v18, s[32:35], s62 offen offset:2048 nt lds
  buffer_load_dwordx4 v19, s[32:35], s62 offen offset:3072 nt lds
  s_add_u32 m0, m0, 4096
  s_nop 0
  buffer_load_dwordx4 v16, s[32:35], s60 offen nt lds
  buffer_load_dwordx4 v17, s[32:35], s60 offen offset:1024 nt lds
  buffer_load_dwordx4 v18, s[32:35], s60 offen offset:2048 nt lds
  buffer_load_dwordx4 v19, s[32:35], s60 offen offset:3072 nt lds
  s_add_u32 s61, s52, 8192
  s_mov_b32 s62, s70
  s_mov_b32 m0, s61
  s_add_u32 s60, s62, 4096
  buffer_load_dwordx4 v20, s[36:39], s62 offen nt lds
  buffer_load_dwordx4 v21, s[36:39], s62 offen offset:1024 nt lds
  buffer_load_dwordx4 v20, s[36:39], s62 offen offset:2048 nt lds
  buffer_load_dwordx4 v21, s[36:39], s62 offen offset:3072 nt lds
  s_add_u32 m0, m0, 4096
  s_nop 0
  buffer_load_dwordx4 v20, s[36:39], s60 offen nt lds
  buffer_load_dwordx4 v21, s[36:39], s60 offen offset:1024 nt lds
  buffer_load_dwordx4 v20, s[36:39], s60 offen offset:2048 nt lds
  buffer_load_dwordx4 v21, s[36:39], s60 offen offset:3072 nt lds
concat_heads__gqa_block_cached__mha_block_cached__near_ridge_kernel_b01:
  s_add_u32 s61, s52, 16384
  s_add_u32 s62, s70, 16384
  s_and_b32 s62, s62, 524287
  s_mov_b32 m0, s61
  s_add_u32 s60, s62, 4096
  buffer_load_dwordx4 v16, s[32:35], s62 offen nt lds
  buffer_load_dwordx4 v17, s[32:35], s62 offen offset:1024 nt lds
  buffer_load_dwordx4 v18, s[32:35], s62 offen offset:2048 nt lds
  buffer_load_dwordx4 v19, s[32:35], s62 offen offset:3072 nt lds
  s_add_u32 m0, m0, 4096
  s_nop 0
  buffer_load_dwordx4 v16, s[32:35], s60 offen nt lds
  buffer_load_dwordx4 v17, s[32:35], s60 offen offset:1024 nt lds
  buffer_load_dwordx4 v18, s[32:35], s60 offen offset:2048 nt lds
  buffer_load_dwordx4 v19, s[32:35], s60 offen offset:3072 nt lds
  s_waitcnt vmcnt(16)
  ds_read_b128 v[132:135], v4
  ds_read_b128 v[136:139], v5
  ds_read_b128 v[140:143], v6
  ds_read_b128 v[144:147], v7
  ds_read_b128 v[148:151], v4 offset:4096
  ds_read_b128 v[152:155], v5 offset:4096
  ds_read_b128 v[156:159], v6 offset:4096
  ds_read_b128 v[160:163], v7 offset:4096
  s_waitcnt lgkmcnt(0)
  s_mov_b32 m0, s52
  s_add_u32 s60, s58, 4096
  buffer_load_dwordx4 v20, s[36:39], s58 offen nt lds
  buffer_load_dwordx4 v21, s[36:39], s58 offen offset:1024 nt lds
  buffer_load_dwordx4 v20, s[36:39], s58 offen offset:2048 nt lds
  buffer_load_dwordx4 v21, s[36:39], s58 offen offset:3072 nt lds
  s_add_u32 m0, m0, 4096
  s_nop 0
  buffer_load_dwordx4 v20, s[36:39], s60 offen nt lds
  buffer_load_dwordx4 v21, s[36:39], s60 offen offset:1024 nt lds
  buffer_load_dwordx4 v20, s[36:39], s60 offen offset:2048 nt lds
  buffer_load_dwordx4 v21, s[36:39], s60 offen offset:3072 nt lds
  s_add_u32 s58, s58, 16384
  s_cmp_lg_u32 s16, 0
  s_cbranch_scc1 concat_heads__gqa_block_cached__mha_block_cached__near_ridge_kernel_havemaxB
  v_mfma_f32_16x16x32_bf16 v[32:35], v[132:135], a[160:163], 0
  v_mfma_f32_16x16x32_bf16 v[32:35], v[136:139], a[164:167], v[32:35]
  v_mfma_f32_16x16x32_bf16 v[32:35], v[140:143], a[168:171], v[32:35]
  v_mfma_f32_16x16x32_bf16 v[32:35], v[144:147], a[172:175], v[32:35]
  v_mfma_f32_16x16x32_bf16 v[36:39], v[148:151], a[160:163], 0
  v_mfma_f32_16x16x32_bf16 v[36:39], v[152:155], a[164:167], v[36:39]
  v_mfma_f32_16x16x32_bf16 v[36:39], v[156:159], a[168:171], v[36:39]
  v_mfma_f32_16x16x32_bf16 v[36:39], v[160:163], a[172:175], v[36:39]
  v_mfma_f32_16x16x32_bf16 v[40:43], v[132:135], a[176:179], 0
  v_mfma_f32_16x16x32_bf16 v[40:43], v[136:139], a[180:183], v[40:43]
  v_mfma_f32_16x16x32_bf16 v[40:43], v[140:143], a[184:187], v[40:43]
  v_mfma_f32_16x16x32_bf16 v[40:43], v[144:147], a[188:191], v[40:43]
  v_mfma_f32_16x16x32_bf16 v[44:47], v[148:151], a[176:179], 0
  v_mfma_f32_16x16x32_bf16 v[44:47], v[152:155], a[180:183], v[44:47]
  v_mfma_f32_16x16x32_bf16 v[44:47], v[156:159], a[184:187], v[44:47]
  v_mfma_f32_16x16x32_bf16 v[44:47], v[160:163], a[188:191], v[44:47]
  v_mfma_f32_16x16x32_bf16 v[48:51], v[132:135], a[192:195], 0
  v_mfma_f32_16x16x32_bf16 v[48:51], v[136:139], a[196:199], v[48:51]
  v_mfma_f32_16x16x32_bf16 v[48:51], v[140:143], a[200:203], v[48:51]
  v_mfma_f32_16x16x32_bf16 v[48:51], v[144:147], a[204:207], v[48:51]
  v_mfma_f32_16x16x32_bf16 v[52:55], v[148:151], a[192:195], 0
  v_mfma_f32_16x16x32_bf16 v[52:55], v[152:155], a[196:199], v[52:55]
  v_mfma_f32_16x16x32_bf16 v[52:55], v[156:159], a[200:203], v[52:55]
  v_mfma_f32_16x16x32_bf16 v[52:55], v[160:163], a[204:207], v[52:55]
  v_mfma_f32_16x16x32_bf16 v[56:59], v[132:135], a[208:211], 0
  v_mfma_f32_16x16x32_bf16 v[56:59], v[136:139], a[212:215], v[56:59]
  v_mfma_f32_16x16x32_bf16 v[56:59], v[140:143], a[216:219], v[56:59]
  v_mfma_f32_16x16x32_bf16 v[56:59], v[144:147], a[220:223], v[56:59]
  v_mfma_f32_16x16x32_bf16 v[60:63], v[148:151], a[208:211], 0
  v_mfma_f32_16x16x32_bf16 v[60:63], v[152:155], a[212:215], v[60:63]
  v_mfma_f32_16x16x32_bf16 v[60:63], v[156:159], a[216:219], v[60:63]
  v_mfma_f32_16x16x32_bf16 v[60:63], v[160:163], a[220:223], v[60:63]
  v_mfma_f32_16x16x32_bf16 v[64:67], v[132:135], a[224:227], 0
  v_mfma_f32_16x16x32_bf16 v[64:67], v[136:139], a[228:231], v[64:67]
  v_mfma_f32_16x16x32_bf16 v[64:67], v[140:143], a[232:235], v[64:67]
  v_mfma_f32_16x16x32_bf16 v[64:67], v[144:147], a[236:239], v[64:67]
  v_mfma_f32_16x16x32_bf16 v[68:71], v[148:151], a[224:227], 0
  v_mfma_f32_16x16x32_bf16 v[68:71], v[152:155], a[228:231], v[68:71]
  v_mfma_f32_16x16x32_bf16 v[68:71], v[156:159], a[232:235], v[68:71]
  v_mfma_f32_16x16x32_bf16 v[68:71], v[160:163], a[236:239], v[68:71]
  s_nop 7
  v_xor_b32 v22, 16, v1
  v_lshlrev_b32 v22, 2, v22
  v_xor_b32 v23, 32, v1
  v_lshlrev_b32 v23, 2, v23
  v_max3_f32 v32, v32, v33, v34
  v_max3_f32 v35, v35, v36, v37
  v_max3_f32 v32, v32, v38, v39
  v_max_f32 v32, v32, v35
  v_max3_f32 v40, v40, v41, v42
  v_max3_f32 v43, v43, v44, v45
  v_max3_f32 v40, v40, v46, v47
  v_max_f32 v40, v40, v43
  v_max3_f32 v48, v48, v49, v50
  v_max3_f32 v51, v51, v52, v53
  v_max3_f32 v48, v48, v54, v55
  v_max_f32 v48, v48, v51
  v_max3_f32 v56, v56, v57, v58
  v_max3_f32 v59, v59, v60, v61
  v_max3_f32 v56, v56, v62, v63
  v_max_f32 v56, v56, v59
  v_max3_f32 v64, v64, v65, v66
  v_max3_f32 v67, v67, v68, v69
  v_max3_f32 v64, v64, v70, v71
  v_max_f32 v64, v64, v67
  ds_bpermute_b32 v33, v22, v32
  ds_bpermute_b32 v41, v22, v40
  ds_bpermute_b32 v49, v22, v48
  ds_bpermute_b32 v57, v22, v56
  ds_bpermute_b32 v65, v22, v64
  s_waitcnt lgkmcnt(0)
  v_max_f32 v32, v32, v33
  v_max_f32 v40, v40, v41
  v_max_f32 v48, v48, v49
  v_max_f32 v56, v56, v57
  v_max_f32 v64, v64, v65
  ds_bpermute_b32 v33, v23, v32
  ds_bpermute_b32 v41, v23, v40
  ds_bpermute_b32 v49, v23, v48
  ds_bpermute_b32 v57, v23, v56
  ds_bpermute_b32 v65, v23, v64
  s_waitcnt lgkmcnt(0)
  v_max_f32 v32, v32, v33
  v_sub_f32 v92, 0, v32
  v_sub_f32 v93, 0, v32
  v_sub_f32 v94, 0, v32
  v_sub_f32 v95, 0, v32
  v_max_f32 v40, v40, v41
  v_sub_f32 v96, 0, v40
  v_sub_f32 v97, 0, v40
  v_sub_f32 v98, 0, v40
  v_sub_f32 v99, 0, v40
  v_max_f32 v48, v48, v49
  v_sub_f32 v100, 0, v48
  v_sub_f32 v101, 0, v48
  v_sub_f32 v102, 0, v48
  v_sub_f32 v103, 0, v48
  v_max_f32 v56, v56, v57
  v_sub_f32 v104, 0, v56
  v_sub_f32 v105, 0, v56
  v_sub_f32 v106, 0, v56
  v_sub_f32 v107, 0, v56
  v_max_f32 v64, v64, v65
  v_sub_f32 v108, 0, v64
  v_sub_f32 v109, 0, v64
  v_sub_f32 v110, 0, v64
  v_sub_f32 v111, 0, v64
concat_heads__gqa_block_cached__mha_block_cached__near_ridge_kernel_havemaxB:
  s_nop 1
  v_mfma_f32_16x16x32_bf16 v[32:35], v[132:135], a[160:163], v[92:95]
  v_accvgpr_write_b32 a12, 0
  v_accvgpr_write_b32 a13, 0
  v_accvgpr_write_b32 a14, 0
  v_accvgpr_write_b32 a15, 0
  v_mfma_f32_16x16x32_bf16 v[32:35], v[136:139], a[164:167], v[32:35]
  v_accvgpr_write_b32 a32, 0
  v_accvgpr_write_b32 a33, 0
  v_accvgpr_write_b32 a34, 0
  v_accvgpr_write_b32 a35, 0
  v_mfma_f32_16x16x32_bf16 v[32:35], v[140:143], a[168:171], v[32:35]
  v_accvgpr_write_b32 a52, 0
  v_accvgpr_write_b32 a53, 0
  v_accvgpr_write_b32 a54, 0
  v_accvgpr_write_b32 a55, 0
  v_mfma_f32_16x16x32_bf16 v[32:35], v[144:147], a[172:175], v[32:35]
  v_accvgpr_write_b32 a72, 0
  v_accvgpr_write_b32 a73, 0
  v_accvgpr_write_b32 a74, 0
  v_accvgpr_write_b32 a75, 0
  v_mfma_f32_16x16x32_bf16 v[36:39], v[148:151], a[160:163], v[92:95]
  v_accvgpr_write_b32 a92, 0
  v_accvgpr_write_b32 a93, 0
  v_accvgpr_write_b32 a94, 0
  v_accvgpr_write_b32 a95, 0
  v_mfma_f32_16x16x32_bf16 v[36:39], v[152:155], a[164:167], v[36:39]
  v_accvgpr_write_b32 a112, 0
  v_accvgpr_write_b32 a113, 0
  v_accvgpr_write_b32 a114, 0
  v_accvgpr_write_b32 a115, 0
  v_mfma_f32_16x16x32_bf16 v[36:39], v[156:159], a[168:171], v[36:39]
  v_accvgpr_write_b32 a132, 0
  v_accvgpr_write_b32 a133, 0
  v_accvgpr_write_b32 a134, 0
  v_accvgpr_write_b32 a135, 0
  v_mfma_f32_16x16x32_bf16 v[36:39], v[160:163], a[172:175], v[36:39]
  v_accvgpr_write_b32 a152, 0
  v_accvgpr_write_b32 a153, 0
  v_accvgpr_write_b32 a154, 0
  v_accvgpr_write_b32 a155, 0
  s_waitcnt vmcnt(16)
  v_mfma_f32_16x16x32_bf16 v[40:43], v[132:135], a[176:179], v[96:99]
  ds_read_b64_tr_b16 v[164:165], v8
  ds_read_b64_tr_b16 v[166:167], v8 offset:4096
  v_accvgpr_write_b32 a16, 0
  v_accvgpr_write_b32 a17, 0
  v_accvgpr_write_b32 a18, 0
  v_accvgpr_write_b32 a19, 0
  v_mfma_f32_16x16x32_bf16 v[40:43], v[136:139], a[180:183], v[40:43]
  ds_read_b64_tr_b16 v[168:169], v9
  ds_read_b64_tr_b16 v[170:171], v9 offset:4096
  v_accvgpr_write_b32 a36, 0
  v_accvgpr_write_b32 a37, 0
  v_accvgpr_write_b32 a38, 0
  v_accvgpr_write_b32 a39, 0
  v_mfma_f32_16x16x32_bf16 v[40:43], v[140:143], a[184:187], v[40:43]
  ds_read_b64_tr_b16 v[172:173], v10
  ds_read_b64_tr_b16 v[174:175], v10 offset:4096
  v_accvgpr_write_b32 a56, 0
  v_accvgpr_write_b32 a57, 0
  v_accvgpr_write_b32 a58, 0
  v_accvgpr_write_b32 a59, 0
  v_mfma_f32_16x16x32_bf16 v[40:43], v[144:147], a[188:191], v[40:43]
  ds_read_b64_tr_b16 v[176:177], v11
  ds_read_b64_tr_b16 v[178:179], v11 offset:4096
  v_accvgpr_write_b32 a76, 0
  v_accvgpr_write_b32 a77, 0
  v_accvgpr_write_b32 a78, 0
  v_accvgpr_write_b32 a79, 0
  v_mfma_f32_16x16x32_bf16 v[44:47], v[148:151], a[176:179], v[96:99]
  ds_read_b64_tr_b16 v[180:181], v12
  ds_read_b64_tr_b16 v[182:183], v12 offset:4096
  v_accvgpr_write_b32 a96, 0
  v_accvgpr_write_b32 a97, 0
  v_accvgpr_write_b32 a98, 0
  v_accvgpr_write_b32 a99, 0
  v_mfma_f32_16x16x32_bf16 v[44:47], v[152:155], a[180:183], v[44:47]
  ds_read_b64_tr_b16 v[184:185], v13
  ds_read_b64_tr_b16 v[186:187], v13 offset:4096
  v_accvgpr_write_b32 a116, 0
  v_accvgpr_write_b32 a117, 0
  v_accvgpr_write_b32 a118, 0
  v_accvgpr_write_b32 a119, 0
  v_mfma_f32_16x16x32_bf16 v[44:47], v[156:159], a[184:187], v[44:47]
  ds_read_b64_tr_b16 v[188:189], v14
  ds_read_b64_tr_b16 v[190:191], v14 offset:4096
  v_accvgpr_write_b32 a136, 0
  v_accvgpr_write_b32 a137, 0
  v_accvgpr_write_b32 a138, 0
  v_accvgpr_write_b32 a139, 0
  v_mfma_f32_16x16x32_bf16 v[44:47], v[160:163], a[188:191], v[44:47]
  ds_read_b64_tr_b16 v[192:193], v15
  ds_read_b64_tr_b16 v[194:195], v15 offset:4096
  v_accvgpr_write_b32 a156, 0
  v_accvgpr_write_b32 a157, 0
  v_accvgpr_write_b32 a158, 0
  v_accvgpr_write_b32 a159, 0
  v_exp_f32 v32, v32
  v_exp_f32 v33, v33
  v_exp_f32 v34, v34
  v_cvt_pk_bf16_f32 v72, v32, v33
  v_exp_f32 v35, v35
  v_exp_f32 v36, v36
  v_cvt_pk_bf16_f32 v73, v34, v35
  v_exp_f32 v37, v37
  v_exp_f32 v38, v38
  v_cvt_pk_bf16_f32 v74, v36, v37
  v_exp_f32 v39, v39
  s_nop 0
  v_cvt_pk_bf16_f32 v75, v38, v39
  v_mfma_f32_16x16x32_bf16 v[48:51], v[132:135], a[192:195], v[100:103]
  s_add_u32 s74, s52, s54
  s_add_u32 s61, s54, 16384
  s_cmp_ge_u32 s61, 24576
  s_cselect_b32 s56, s69, s68
  s_add_u32 s54, s54, s56
  v_mfma_f32_16x16x32_bf16 v[48:51], v[136:139], a[196:199], v[48:51]
  v_mfma_f32_16x16x32_bf16 v[48:51], v[140:143], a[200:203], v[48:51]
  v_exp_f32 v40, v40
  v_mfma_f32_16x16x32_bf16 v[48:51], v[144:147], a[204:207], v[48:51]
  v_exp_f32 v41, v41
  v_mfma_f32_16x16x32_bf16 v[52:55], v[148:151], a[192:195], v[100:103]
  v_exp_f32 v42, v42
  v_mfma_f32_16x16x32_bf16 v[52:55], v[152:155], a[196:199], v[52:55]
  v_cvt_pk_bf16_f32 v76, v40, v41
  v_mfma_f32_16x16x32_bf16 v[52:55], v[156:159], a[200:203], v[52:55]
  v_exp_f32 v43, v43
  v_mfma_f32_16x16x32_bf16 v[52:55], v[160:163], a[204:207], v[52:55]
  v_exp_f32 v44, v44
  s_waitcnt lgkmcnt(0)
  v_mfma_f32_16x16x32_bf16 a[0:3], v[164:167], v[72:75], 0
  v_cvt_pk_bf16_f32 v77, v42, v43
  v_add_u32 v8, s56, v8
  v_mfma_f32_16x16x32_bf16 a[20:23], v[168:171], v[72:75], 0
  v_exp_f32 v45, v45
  v_add_u32 v9, s56, v9
  s_mov_b32 m0, s74
  s_add_u32 s60, s57, 4096
  buffer_load_dwordx4 v16, s[32:35], s57 offen nt lds
  v_mfma_f32_16x16x32_bf16 a[40:43], v[172:175], v[72:75], 0
  v_exp_f32 v46, v46
  v_add_u32 v10, s56, v10
  v_mfma_f32_16x16x32_bf16 a[60:63], v[176:179], v[72:75], 0
  v_cvt_pk_bf16_f32 v78, v44, v45
  v_add_u32 v11, s56, v11
  v_mfma_f32_16x16x32_bf16 a[80:83], v[180:183], v[72:75], 0
  v_exp_f32 v47, v47
  v_add_u32 v12, s56, v12
  v_mfma_f32_16x16x32_bf16 a[100:103], v[184:187], v[72:75], 0
  v_cvt_pk_bf16_f32 v79, v46, v47
  v_add_u32 v13, s56, v13
  buffer_load_dwordx4 v17, s[32:35], s57 offen offset:1024 nt lds
  v_mfma_f32_16x16x32_bf16 a[120:123], v[188:191], v[72:75], 0
  v_add_u32 v14, s56, v14
  v_mfma_f32_16x16x32_bf16 a[140:143], v[192:195], v[72:75], 0
  v_add_u32 v15, s56, v15
  v_mfma_f32_16x16x32_bf16 v[112:115], v[196:199], v[72:75], 0
  v_mfma_f32_16x16x32_bf16 v[56:59], v[132:135], a[208:211], v[104:107]
  v_exp_f32 v48, v48
  v_mfma_f32_16x16x32_bf16 v[56:59], v[136:139], a[212:215], v[56:59]
  v_exp_f32 v49, v49
  buffer_load_dwordx4 v18, s[32:35], s57 offen offset:2048 nt lds
  v_mfma_f32_16x16x32_bf16 v[56:59], v[140:143], a[216:219], v[56:59]
  v_exp_f32 v50, v50
  v_mfma_f32_16x16x32_bf16 v[56:59], v[144:147], a[220:223], v[56:59]
  v_cvt_pk_bf16_f32 v80, v48, v49
  v_mfma_f32_16x16x32_bf16 v[60:63], v[148:151], a[208:211], v[104:107]
  v_exp_f32 v51, v51
  v_mfma_f32_16x16x32_bf16 v[60:63], v[152:155], a[212:215], v[60:63]
  v_exp_f32 v52, v52
  buffer_load_dwordx4 v19, s[32:35], s57 offen offset:3072 nt lds
  v_mfma_f32_16x16x32_bf16 v[60:63], v[156:159], a[216:219], v[60:63]
  v_cvt_pk_bf16_f32 v81, v50, v51
  v_mfma_f32_16x16x32_bf16 v[60:63], v[160:163], a[220:223], v[60:63]
  v_exp_f32 v53, v53
  v_mfma_f32_16x16x32_bf16 a[4:7], v[164:167], v[76:79], 0
  v_exp_f32 v54, v54
  v_mfma_f32_16x16x32_bf16 a[24:27], v[168:171], v[76:79], 0
  v_cvt_pk_bf16_f32 v82, v52, v53
  s_add_u32 m0, m0, 4096
  s_nop 0
  buffer_load_dwordx4 v16, s[32:35], s60 offen nt lds
  v_mfma_f32_16x16x32_bf16 a[44:47], v[172:175], v[76:79], 0
  v_exp_f32 v55, v55
  v_mfma_f32_16x16x32_bf16 a[64:67], v[176:179], v[76:79], 0
  v_cvt_pk_bf16_f32 v83, v54, v55
  v_mfma_f32_16x16x32_bf16 a[84:87], v[180:183], v[76:79], 0
  v_mfma_f32_16x16x32_bf16 a[104:107], v[184:187], v[76:79], 0
  buffer_load_dwordx4 v17, s[32:35], s60 offen offset:1024 nt lds
  v_mfma_f32_16x16x32_bf16 a[124:127], v[188:191], v[76:79], 0
  v_mfma_f32_16x16x32_bf16 a[144:147], v[192:195], v[76:79], 0
  v_mfma_f32_16x16x32_bf16 v[116:119], v[196:199], v[76:79], 0
  v_mfma_f32_16x16x32_bf16 v[64:67], v[132:135], a[224:227], v[108:111]
  v_exp_f32 v56, v56
  s_add_u32 s61, s53, 16384
  s_cmp_ge_u32 s61, 24576
  s_cselect_b32 s55, s69, s68
  s_add_u32 s53, s53, s55
  v_mfma_f32_16x16x32_bf16 v[64:67], v[136:139], a[228:231], v[64:67]
  v_exp_f32 v57, v57
  buffer_load_dwordx4 v18, s[32:35], s60 offen offset:2048 nt lds
  v_mfma_f32_16x16x32_bf16 v[64:67], v[140:143], a[232:235], v[64:67]
  v_exp_f32 v58, v58
  v_add_u32 v4, s55, v4
  v_add_u32 v5, s55, v5
  v_mfma_f32_16x16x32_bf16 v[64:67], v[144:147], a[236:239], v[64:67]
  v_cvt_pk_bf16_f32 v84, v56, v57
  v_add_u32 v6, s55, v6
  v_add_u32 v7, s55, v7
  v_mfma_f32_16x16x32_bf16 v[68:71], v[148:151], a[224:227], v[108:111]
  v_exp_f32 v59, v59
  v_mfma_f32_16x16x32_bf16 v[68:71], v[152:155], a[228:231], v[68:71]
  v_exp_f32 v60, v60
  buffer_load_dwordx4 v19, s[32:35], s60 offen offset:3072 nt lds
  s_add_u32 s57, s57, 16384
  v_mfma_f32_16x16x32_bf16 v[68:71], v[156:159], a[232:235], v[68:71]
  v_cvt_pk_bf16_f32 v85, v58, v59
  v_mfma_f32_16x16x32_bf16 v[68:71], v[160:163], a[236:239], v[68:71]
  v_exp_f32 v61, v61
  s_waitcnt vmcnt(16)
  ds_read_b128 v[132:135], v4
  ds_read_b128 v[136:139], v5
  v_mfma_f32_16x16x32_bf16 a[8:11], v[164:167], v[80:83], 0
  v_exp_f32 v62, v62
  ds_read_b128 v[140:143], v6
  ds_read_b128 v[144:147], v7
  v_mfma_f32_16x16x32_bf16 a[28:31], v[168:171], v[80:83], 0
  v_cvt_pk_bf16_f32 v86, v60, v61
  ds_read_b128 v[148:151], v4 offset:4096
  ds_read_b128 v[152:155], v5 offset:4096
  v_mfma_f32_16x16x32_bf16 a[48:51], v[172:175], v[80:83], 0
  v_exp_f32 v63, v63
  ds_read_b128 v[156:159], v6 offset:4096
  ds_read_b128 v[160:163], v7 offset:4096
  v_mfma_f32_16x16x32_bf16 a[68:71], v[176:179], v[80:83], 0
  v_cvt_pk_bf16_f32 v87, v62, v63
  v_mfma_f32_16x16x32_bf16 a[88:91], v[180:183], v[80:83], 0
  v_mfma_f32_16x16x32_bf16 a[108:111], v[184:187], v[80:83], 0
  v_mfma_f32_16x16x32_bf16 a[128:131], v[188:191], v[80:83], 0
  v_mfma_f32_16x16x32_bf16 a[148:151], v[192:195], v[80:83], 0
  v_mfma_f32_16x16x32_bf16 v[120:123], v[196:199], v[80:83], 0
  s_mov_b32 s63, 31
concat_heads__gqa_block_cached__mha_block_cached__near_ridge_kernel_loop:
  v_mfma_f32_16x16x32_bf16 a[12:15], v[164:167], v[84:87], a[12:15]
  v_exp_f32 v64, v64
  v_exp_f32 v65, v65
  v_mfma_f32_16x16x32_bf16 a[32:35], v[168:171], v[84:87], a[32:35]
  v_exp_f32 v66, v66
  v_mfma_f32_16x16x32_bf16 a[52:55], v[172:175], v[84:87], a[52:55]
  v_cvt_pk_bf16_f32 v88, v64, v65
  v_mfma_f32_16x16x32_bf16 a[72:75], v[176:179], v[84:87], a[72:75]
  v_exp_f32 v67, v67
  v_exp_f32 v68, v68
  v_mfma_f32_16x16x32_bf16 a[92:95], v[180:183], v[84:87], a[92:95]
  v_cvt_pk_bf16_f32 v89, v66, v67
  v_mfma_f32_16x16x32_bf16 a[112:115], v[184:187], v[84:87], a[112:115]
  v_exp_f32 v69, v69
  v_mfma_f32_16x16x32_bf16 a[132:135], v[188:191], v[84:87], a[132:135]
  v_exp_f32 v70, v70
  v_cvt_pk_bf16_f32 v90, v68, v69
  v_mfma_f32_16x16x32_bf16 a[152:155], v[192:195], v[84:87], a[152:155]
  v_exp_f32 v71, v71
  v_mfma_f32_16x16x32_bf16 v[124:127], v[196:199], v[84:87], v[124:127]
  v_cvt_pk_bf16_f32 v91, v70, v71
  s_waitcnt lgkmcnt(0)
  v_mfma_f32_16x16x32_bf16 v[32:35], v[132:135], a[160:163], v[92:95]
  v_mfma_f32_16x16x32_bf16 v[32:35], v[136:139], a[164:167], v[32:35]
  s_add_u32 s59, s52, s53
  s_mov_b32 m0, s59
  s_add_u32 s60, s58, 4096
  buffer_load_dwordx4 v20, s[36:39], s58 offen nt lds
  v_mfma_f32_16x16x32_bf16 v[32:35], v[140:143], a[168:171], v[32:35]
  v_mfma_f32_16x16x32_bf16 v[32:35], v[144:147], a[172:175], v[32:35]
  v_mfma_f32_16x16x32_bf16 v[36:39], v[148:151], a[160:163], v[92:95]
  v_mfma_f32_16x16x32_bf16 v[36:39], v[152:155], a[164:167], v[36:39]
  buffer_load_dwordx4 v21, s[36:39], s58 offen offset:1024 nt lds
  v_mfma_f32_16x16x32_bf16 v[36:39], v[156:159], a[168:171], v[36:39]
  v_mfma_f32_16x16x32_bf16 v[36:39], v[160:163], a[172:175], v[36:39]
  s_waitcnt vmcnt(10)
  v_mfma_f32_16x16x32_bf16 a[16:19], v[164:167], v[88:91], a[16:19]
  ds_read_b64_tr_b16 v[164:165], v8
  ds_read_b64_tr_b16 v[166:167], v8 offset:4096
  v_mfma_f32_16x16x32_bf16 a[36:39], v[168:171], v[88:91], a[36:39]
  ds_read_b64_tr_b16 v[168:169], v9
  ds_read_b64_tr_b16 v[170:171], v9 offset:4096
  v_mfma_f32_16x16x32_bf16 a[56:59], v[172:175], v[88:91], a[56:59]
  ds_read_b64_tr_b16 v[172:173], v10
  ds_read_b64_tr_b16 v[174:175], v10 offset:4096
  buffer_load_dwordx4 v20, s[36:39], s58 offen offset:2048 nt lds
  v_mfma_f32_16x16x32_bf16 a[76:79], v[176:179], v[88:91], a[76:79]
  ds_read_b64_tr_b16 v[176:177], v11
  ds_read_b64_tr_b16 v[178:179], v11 offset:4096
  v_exp_f32 v32, v32
  v_mfma_f32_16x16x32_bf16 a[96:99], v[180:183], v[88:91], a[96:99]
  ds_read_b64_tr_b16 v[180:181], v12
  ds_read_b64_tr_b16 v[182:183], v12 offset:4096
  v_exp_f32 v33, v33
  v_mfma_f32_16x16x32_bf16 a[116:119], v[184:187], v[88:91], a[116:119]
  ds_read_b64_tr_b16 v[184:185], v13
  ds_read_b64_tr_b16 v[186:187], v13 offset:4096
  v_exp_f32 v34, v34
  v_mfma_f32_16x16x32_bf16 a[136:139], v[188:191], v[88:91], a[136:139]
  ds_read_b64_tr_b16 v[188:189], v14
  ds_read_b64_tr_b16 v[190:191], v14 offset:4096
  v_cvt_pk_bf16_f32 v72, v32, v33
  buffer_load_dwordx4 v21, s[36:39], s58 offen offset:3072 nt lds
  v_mfma_f32_16x16x32_bf16 a[156:159], v[192:195], v[88:91], a[156:159]
  ds_read_b64_tr_b16 v[192:193], v15
  ds_read_b64_tr_b16 v[194:195], v15 offset:4096
  v_exp_f32 v35, v35
  v_mfma_f32_16x16x32_bf16 v[128:131], v[196:199], v[88:91], v[128:131]
  v_exp_f32 v36, v36
  v_mfma_f32_16x16x32_bf16 v[40:43], v[132:135], a[176:179], v[96:99]
  v_mfma_f32_16x16x32_bf16 v[40:43], v[136:139], a[180:183], v[40:43]
  v_cvt_pk_bf16_f32 v73, v34, v35
  s_add_u32 m0, m0, 4096
  s_nop 0
  buffer_load_dwordx4 v20, s[36:39], s60 offen nt lds
  v_mfma_f32_16x16x32_bf16 v[40:43], v[140:143], a[184:187], v[40:43]
  v_exp_f32 v37, v37
  v_mfma_f32_16x16x32_bf16 v[40:43], v[144:147], a[188:191], v[40:43]
  v_exp_f32 v38, v38
  v_mfma_f32_16x16x32_bf16 v[44:47], v[148:151], a[176:179], v[96:99]
  v_cvt_pk_bf16_f32 v74, v36, v37
  v_mfma_f32_16x16x32_bf16 v[44:47], v[152:155], a[180:183], v[44:47]
  v_exp_f32 v39, v39
  buffer_load_dwordx4 v21, s[36:39], s60 offen offset:1024 nt lds
  v_mfma_f32_16x16x32_bf16 v[44:47], v[156:159], a[184:187], v[44:47]
  v_cvt_pk_bf16_f32 v75, v38, v39
  v_mfma_f32_16x16x32_bf16 v[44:47], v[160:163], a[188:191], v[44:47]
  v_mfma_f32_16x16x32_bf16 v[48:51], v[132:135], a[192:195], v[100:103]
  s_add_u32 s74, s52, s54
  s_add_u32 s61, s54, 16384
  s_cmp_ge_u32 s61, 24576
  s_cselect_b32 s56, s69, s68
  s_add_u32 s54, s54, s56
  v_mfma_f32_16x16x32_bf16 v[48:51], v[136:139], a[196:199], v[48:51]
  buffer_load_dwordx4 v20, s[36:39], s60 offen offset:2048 nt lds
  v_mfma_f32_16x16x32_bf16 v[48:51], v[140:143], a[200:203], v[48:51]
  v_exp_f32 v40, v40
  v_mfma_f32_16x16x32_bf16 v[48:51], v[144:147], a[204:207], v[48:51]
  v_exp_f32 v41, v41
  v_mfma_f32_16x16x32_bf16 v[52:55], v[148:151], a[192:195], v[100:103]
  v_exp_f32 v42, v42
  v_mfma_f32_16x16x32_bf16 v[52:55], v[152:155], a[196:199], v[52:55]
  v_cvt_pk_bf16_f32 v76, v40, v41
  buffer_load_dwordx4 v21, s[36:39], s60 offen offset:3072 nt lds
  s_add_u32 s58, s58, 16384
  v_mfma_f32_16x16x32_bf16 v[52:55], v[156:159], a[200:203], v[52:55]
  v_exp_f32 v43, v43
  v_mfma_f32_16x16x32_bf16 v[52:55], v[160:163], a[204:207], v[52:55]
  v_exp_f32 v44, v44
  s_waitcnt lgkmcnt(0)
  v_mfma_f32_16x16x32_bf16 a[0:3], v[164:167], v[72:75], a[0:3]
  v_cvt_pk_bf16_f32 v77, v42, v43
  v_add_u32 v8, s56, v8
  v_mfma_f32_16x16x32_bf16 a[20:23], v[168:171], v[72:75], a[20:23]
  v_exp_f32 v45, v45
  v_add_u32 v9, s56, v9
  s_mov_b32 m0, s74
  s_add_u32 s60, s57, 4096
  buffer_load_dwordx4 v16, s[32:35], s57 offen nt lds
  v_mfma_f32_16x16x32_bf16 a[40:43], v[172:175], v[72:75], a[40:43]
  v_exp_f32 v46, v46
  v_add_u32 v10, s56, v10
  v_mfma_f32_16x16x32_bf16 a[60:63], v[176:179], v[72:75], a[60:63]
  v_cvt_pk_bf16_f32 v78, v44, v45
  v_add_u32 v11, s56, v11
  v_mfma_f32_16x16x32_bf16 a[80:83], v[180:183], v[72:75], a[80:83]
  v_exp_f32 v47, v47
  v_add_u32 v12, s56, v12
  v_mfma_f32_16x16x32_bf16 a[100:103], v[184:187], v[72:75], a[100:103]
  v_cvt_pk_bf16_f32 v79, v46, v47
  v_add_u32 v13, s56, v13
  buffer_load_dwordx4 v17, s[32:35], s57 offen offset:1024 nt lds
  v_mfma_f32_16x16x32_bf16 a[120:123], v[188:191], v[72:75], a[120:123]
  v_add_u32 v14, s56, v14
  v_mfma_f32_16x16x32_bf16 a[140:143], v[192:195], v[72:75], a[140:143]
  v_add_u32 v15, s56, v15
  v_mfma_f32_16x16x32_bf16 v[112:115], v[196:199], v[72:75], v[112:115]
  v_mfma_f32_16x16x32_bf16 v[56:59], v[132:135], a[208:211], v[104:107]
  v_exp_f32 v48, v48
  v_mfma_f32_16x16x32_bf16 v[56:59], v[136:139], a[212:215], v[56:59]
  v_exp_f32 v49, v49
  buffer_load_dwordx4 v18, s[32:35], s57 offen offset:2048 nt lds
  v_mfma_f32_16x16x32_bf16 v[56:59], v[140:143], a[216:219], v[56:59]
  v_exp_f32 v50, v50
  v_mfma_f32_16x16x32_bf16 v[56:59], v[144:147], a[220:223], v[56:59]
  v_cvt_pk_bf16_f32 v80, v48, v49
  v_mfma_f32_16x16x32_bf16 v[60:63], v[148:151], a[208:211], v[104:107]
  v_exp_f32 v51, v51
  v_mfma_f32_16x16x32_bf16 v[60:63], v[152:155], a[212:215], v[60:63]
  v_exp_f32 v52, v52
  buffer_load_dwordx4 v19, s[32:35], s57 offen offset:3072 nt lds
  v_mfma_f32_16x16x32_bf16 v[60:63], v[156:159], a[216:219], v[60:63]
  v_cvt_pk_bf16_f32 v81, v50, v51
  v_mfma_f32_16x16x32_bf16 v[60:63], v[160:163], a[220:223], v[60:63]
  v_exp_f32 v53, v53
  v_mfma_f32_16x16x32_bf16 a[4:7], v[164:167], v[76:79], a[4:7]
  v_exp_f32 v54, v54
  v_mfma_f32_16x16x32_bf16 a[24:27], v[168:171], v[76:79], a[24:27]
  v_cvt_pk_bf16_f32 v82, v52, v53
  s_add_u32 m0, m0, 4096
  s_nop 0
  buffer_load_dwordx4 v16, s[32:35], s60 offen nt lds
  v_mfma_f32_16x16x32_bf16 a[44:47], v[172:175], v[76:79], a[44:47]
  v_exp_f32 v55, v55
  v_mfma_f32_16x16x32_bf16 a[64:67], v[176:179], v[76:79], a[64:67]
  v_cvt_pk_bf16_f32 v83, v54, v55
  v_mfma_f32_16x16x32_bf16 a[84:87], v[180:183], v[76:79], a[84:87]
  v_mfma_f32_16x16x32_bf16 a[104:107], v[184:187], v[76:79], a[104:107]
  buffer_load_dwordx4 v17, s[32:35], s60 offen offset:1024 nt lds
  v_mfma_f32_16x16x32_bf16 a[124:127], v[188:191], v[76:79], a[124:127]
  v_mfma_f32_16x16x32_bf16 a[144:147], v[192:195], v[76:79], a[144:147]
  v_mfma_f32_16x16x32_bf16 v[116:119], v[196:199], v[76:79], v[116:119]
  v_mfma_f32_16x16x32_bf16 v[64:67], v[132:135], a[224:227], v[108:111]
  v_exp_f32 v56, v56
  s_add_u32 s61, s53, 16384
  s_cmp_ge_u32 s61, 24576
  s_cselect_b32 s55, s69, s68
  s_add_u32 s53, s53, s55
  v_mfma_f32_16x16x32_bf16 v[64:67], v[136:139], a[228:231], v[64:67]
  v_exp_f32 v57, v57
  buffer_load_dwordx4 v18, s[32:35], s60 offen offset:2048 nt lds
  v_mfma_f32_16x16x32_bf16 v[64:67], v[140:143], a[232:235], v[64:67]
  v_exp_f32 v58, v58
  v_add_u32 v4, s55, v4
  v_add_u32 v5, s55, v5
  v_mfma_f32_16x16x32_bf16 v[64:67], v[144:147], a[236:239], v[64:67]
  v_cvt_pk_bf16_f32 v84, v56, v57
  v_add_u32 v6, s55, v6
  v_add_u32 v7, s55, v7
  v_mfma_f32_16x16x32_bf16 v[68:71], v[148:151], a[224:227], v[108:111]
  v_exp_f32 v59, v59
  v_mfma_f32_16x16x32_bf16 v[68:71], v[152:155], a[228:231], v[68:71]
  v_exp_f32 v60, v60
  buffer_load_dwordx4 v19, s[32:35], s60 offen offset:3072 nt lds
  s_add_u32 s57, s57, 16384
  v_mfma_f32_16x16x32_bf16 v[68:71], v[156:159], a[232:235], v[68:71]
  v_cvt_pk_bf16_f32 v85, v58, v59
  v_mfma_f32_16x16x32_bf16 v[68:71], v[160:163], a[236:239], v[68:71]
  v_exp_f32 v61, v61
  s_waitcnt vmcnt(16)
  ds_read_b128 v[132:135], v4
  ds_read_b128 v[136:139], v5
  v_mfma_f32_16x16x32_bf16 a[8:11], v[164:167], v[80:83], a[8:11]
  v_exp_f32 v62, v62
  ds_read_b128 v[140:143], v6
  ds_read_b128 v[144:147], v7
  v_mfma_f32_16x16x32_bf16 a[28:31], v[168:171], v[80:83], a[28:31]
  v_cvt_pk_bf16_f32 v86, v60, v61
  ds_read_b128 v[148:151], v4 offset:4096
  ds_read_b128 v[152:155], v5 offset:4096
  v_mfma_f32_16x16x32_bf16 a[48:51], v[172:175], v[80:83], a[48:51]
  v_exp_f32 v63, v63
  ds_read_b128 v[156:159], v6 offset:4096
  ds_read_b128 v[160:163], v7 offset:4096
  v_mfma_f32_16x16x32_bf16 a[68:71], v[176:179], v[80:83], a[68:71]
  v_cvt_pk_bf16_f32 v87, v62, v63
  v_mfma_f32_16x16x32_bf16 a[88:91], v[180:183], v[80:83], a[88:91]
  v_mfma_f32_16x16x32_bf16 a[108:111], v[184:187], v[80:83], a[108:111]
  v_mfma_f32_16x16x32_bf16 a[128:131], v[188:191], v[80:83], a[128:131]
  v_mfma_f32_16x16x32_bf16 a[148:151], v[192:195], v[80:83], a[148:151]
  v_mfma_f32_16x16x32_bf16 v[120:123], v[196:199], v[80:83], v[120:123]
  s_sub_u32 s63, s63, 1
  s_cmp_lg_u32 s63, 0
  s_cbranch_scc1 concat_heads__gqa_block_cached__mha_block_cached__near_ridge_kernel_loop
concat_heads__gqa_block_cached__mha_block_cached__near_ridge_kernel_tail:
  s_waitcnt vmcnt(0)
  s_barrier
  v_add_u32 v26, s52, v2
  v_lshlrev_b32 v27, 2, v1
  v_add_u32 v28, s52, v27
  v_lshrrev_b32 v22, 4, v1
  v_and_b32 v23, 15, v1
  v_lshlrev_b32 v30, 1, v22
  v_add_u32 v30, 0, v30
  v_xor_b32 v30, v30, v23
  v_lshlrev_b32 v30, 4, v30
  v_lshlrev_b32 v31, 10, v22
  v_add_u32 v4, v31, v30
  v_lshlrev_b32 v30, 1, v22
  v_add_u32 v30, 8, v30
  v_xor_b32 v30, v30, v23
  v_lshlrev_b32 v30, 4, v30
  v_lshlrev_b32 v31, 10, v22
  v_add_u32 v5, v31, v30
  v_add_u32 v24, 6144, v4
  v_add_u32 v25, 9216, v5
  v_add_u32 v5, 3072, v5
  v_mfma_f32_16x16x32_bf16 a[12:15], v[164:167], v[84:87], a[12:15]
  v_exp_f32 v64, v64
  v_exp_f32 v65, v65
  s_add_u32 m0, s52, 24576
  s_mov_b32 s60, 0
  buffer_load_dwordx4 v4, s[80:83], s60 offen  lds
  v_mfma_f32_16x16x32_bf16 a[32:35], v[168:171], v[84:87], a[32:35]
  v_exp_f32 v66, v66
  ds_write_b128 v26, a[80:83] offset:0
  buffer_load_dwordx4 v5, s[80:83], s60 offen offset:1024  lds
  v_mfma_f32_16x16x32_bf16 a[52:55], v[172:175], v[84:87], a[52:55]
  v_cvt_pk_bf16_f32 v88, v64, v65
  ds_write_b128 v26, a[100:103] offset:5120
  buffer_load_dwordx4 v24, s[80:83], s60 offen offset:2048  lds
  v_mfma_f32_16x16x32_bf16 a[72:75], v[176:179], v[84:87], a[72:75]
  v_exp_f32 v67, v67
  v_exp_f32 v68, v68
  ds_write_b128 v26, a[120:123] offset:10240
  buffer_load_dwordx4 v25, s[80:83], s60 offen offset:3072  lds
  v_mfma_f32_16x16x32_bf16 a[92:95], v[180:183], v[84:87], a[92:95]
  v_cvt_pk_bf16_f32 v89, v66, v67
  ds_write_b128 v26, a[140:143] offset:15360
  s_add_u32 m0, s52, 28672
  s_mov_b32 s60, 16384
  buffer_load_dwordx4 v4, s[80:83], s60 offen  lds
  v_mfma_f32_16x16x32_bf16 a[112:115], v[184:187], v[84:87], a[112:115]
  v_exp_f32 v69, v69
  ds_write_b128 v26, a[84:87] offset:1024
  buffer_load_dwordx4 v5, s[80:83], s60 offen offset:1024  lds
  v_mfma_f32_16x16x32_bf16 a[132:135], v[188:191], v[84:87], a[132:135]
  v_exp_f32 v70, v70
  v_cvt_pk_bf16_f32 v90, v68, v69
  ds_write_b128 v26, a[104:107] offset:6144
  buffer_load_dwordx4 v24, s[80:83], s60 offen offset:2048  lds
  v_mfma_f32_16x16x32_bf16 a[152:155], v[192:195], v[84:87], a[152:155]
  v_exp_f32 v71, v71
  ds_write_b128 v26, a[124:127] offset:11264
  buffer_load_dwordx4 v25, s[80:83], s60 offen offset:3072  lds
  v_mfma_f32_16x16x32_bf16 v[124:127], v[196:199], v[84:87], v[124:127]
  v_cvt_pk_bf16_f32 v91, v70, v71
  ds_write_b128 v26, a[144:147] offset:16384
  s_nop 1
  v_mfma_f32_16x16x32_bf16 a[16:19], v[164:167], v[88:91], a[16:19]
  ds_write_b128 v26, a[88:91] offset:2048
  ds_write_b128 v26, a[108:111] offset:7168
  s_add_u32 m0, s52, 32768
  s_mov_b32 s60, 32768
  buffer_load_dwordx4 v4, s[80:83], s60 offen  lds
  v_mfma_f32_16x16x32_bf16 a[36:39], v[168:171], v[88:91], a[36:39]
  ds_write_b128 v26, a[128:131] offset:12288
  ds_write_b128 v26, a[148:151] offset:17408
  buffer_load_dwordx4 v5, s[80:83], s60 offen offset:1024  lds
  v_mfma_f32_16x16x32_bf16 a[56:59], v[172:175], v[88:91], a[56:59]
  ds_write_b32 v28, v92 offset:20480
  ds_write_b32 v28, v112 offset:21760
  buffer_load_dwordx4 v24, s[80:83], s60 offen offset:2048  lds
  v_mfma_f32_16x16x32_bf16 a[76:79], v[176:179], v[88:91], a[76:79]
  ds_write_b32 v28, v96 offset:20736
  ds_write_b32 v28, v116 offset:22016
  buffer_load_dwordx4 v25, s[80:83], s60 offen offset:3072  lds
  v_mfma_f32_16x16x32_bf16 a[96:99], v[180:183], v[88:91], a[96:99]
  ds_write_b32 v28, v100 offset:20992
  ds_write_b32 v28, v120 offset:22272
  s_add_u32 m0, s52, 36864
  s_mov_b32 s60, 49152
  buffer_load_dwordx4 v4, s[80:83], s60 offen  lds
  v_mfma_f32_16x16x32_bf16 a[116:119], v[184:187], v[88:91], a[116:119]
  ds_write_b128 v26, a[92:95] offset:3072
  buffer_load_dwordx4 v5, s[80:83], s60 offen offset:1024  lds
  v_mfma_f32_16x16x32_bf16 a[136:139], v[188:191], v[88:91], a[136:139]
  ds_write_b128 v26, a[112:115] offset:8192
  buffer_load_dwordx4 v24, s[80:83], s60 offen offset:2048  lds
  v_mfma_f32_16x16x32_bf16 a[156:159], v[192:195], v[88:91], a[156:159]
  ds_write_b128 v26, a[132:135] offset:13312
  buffer_load_dwordx4 v25, s[80:83], s60 offen offset:3072  lds
  v_mfma_f32_16x16x32_bf16 v[128:131], v[196:199], v[88:91], v[128:131]
  ds_write_b128 v26, a[152:155] offset:18432
  ds_write_b32 v28, v104 offset:21248
  ds_write_b32 v28, v124 offset:22528
  s_nop 5
  ds_write_b128 v26, a[96:99] offset:4096
  ds_write_b128 v26, a[116:119] offset:9216
  ds_write_b128 v26, a[136:139] offset:14336
  ds_write_b128 v26, a[156:159] offset:19456
  ds_write_b32 v28, v108 offset:21504
  ds_write_b32 v28, v128 offset:22784
  v_add_u32 v26, s71, v2
  v_add_u32 v28, s71, v27
  s_waitcnt lgkmcnt(0)
  s_barrier
  ds_read_b32 v32, v28 offset:20480
  ds_read_b32 v40, v28 offset:21760
  ds_read_b32 v33, v28 offset:20736
  ds_read_b32 v41, v28 offset:22016
  ds_read_b32 v34, v28 offset:20992
  ds_read_b32 v42, v28 offset:22272
  ds_read_b32 v35, v28 offset:21248
  ds_read_b32 v43, v28 offset:22528
  ds_read_b32 v36, v28 offset:21504
  ds_read_b32 v44, v28 offset:22784
  ds_read_b128 v[132:135], v26 offset:0
  ds_read_b128 v[136:139], v26 offset:1024
  ds_read_b128 v[140:143], v26 offset:2048
  ds_read_b128 v[144:147], v26 offset:3072
  ds_read_b128 v[148:151], v26 offset:4096
  ds_read_b128 v[152:155], v26 offset:5120
  ds_read_b128 v[156:159], v26 offset:6144
  ds_read_b128 v[160:163], v26 offset:7168
  ds_read_b128 v[164:167], v26 offset:8192
  ds_read_b128 v[168:171], v26 offset:9216
  ds_read_b128 v[172:175], v26 offset:10240
  ds_read_b128 v[176:179], v26 offset:11264
  ds_read_b128 v[180:183], v26 offset:12288
  ds_read_b128 v[184:187], v26 offset:13312
  ds_read_b128 v[188:191], v26 offset:14336
  ds_read_b128 v[192:195], v26 offset:15360
  ds_read_b128 v[196:199], v26 offset:16384
  ds_read_b128 v[200:203], v26 offset:17408
  ds_read_b128 v[204:207], v26 offset:18432
  ds_read_b128 v[208:211], v26 offset:19456
  s_waitcnt lgkmcnt(15)
  s_mov_b64 s[18:19], 0
  v_min_f32 v48, v92, v32
  v_sub_f32 v56, v48, v92
  v_sub_f32 v66, v48, v32
  v_exp_f32 v56, v56
  v_exp_f32 v66, v66
  s_nop 0
  v_mul_f32 v76, v56, v112
  v_fmac_f32 v76, v66, v40
  s_nop 0
  v_cmp_nge_f32 vcc, 0x5f800000, v76
  v_rcp_f32 v76, v76
  s_or_b64 s[18:19], s[18:19], vcc
  s_nop 0
  v_mul_f32 v56, v56, v76
  v_mul_f32 v66, v66, v76
  v_min_f32 v49, v96, v33
  v_sub_f32 v58, v49, v96
  v_sub_f32 v68, v49, v33
  v_exp_f32 v58, v58
  v_exp_f32 v68, v68
  s_nop 0
  v_mul_f32 v77, v58, v116
  v_fmac_f32 v77, v68, v41
  s_nop 0
  v_cmp_nge_f32 vcc, 0x5f800000, v77
  v_rcp_f32 v77, v77
  s_or_b64 s[18:19], s[18:19], vcc
  s_nop 0
  v_mul_f32 v58, v58, v77
  v_mul_f32 v68, v68, v77
  v_min_f32 v50, v100, v34
  v_sub_f32 v60, v50, v100
  v_sub_f32 v70, v50, v34
  v_exp_f32 v60, v60
  v_exp_f32 v70, v70
  s_nop 0
  v_mul_f32 v78, v60, v120
  v_fmac_f32 v78, v70, v42
  s_nop 0
  v_cmp_nge_f32 vcc, 0x5f800000, v78
  v_rcp_f32 v78, v78
  s_or_b64 s[18:19], s[18:19], vcc
  s_nop 0
  v_mul_f32 v60, v60, v78
  v_mul_f32 v70, v70, v78
  v_min_f32 v51, v104, v35
  v_sub_f32 v62, v51, v104
  v_sub_f32 v72, v51, v35
  v_exp_f32 v62, v62
  v_exp_f32 v72, v72
  s_nop 0
  v_mul_f32 v79, v62, v124
  v_fmac_f32 v79, v72, v43
  s_nop 0
  v_cmp_nge_f32 vcc, 0x5f800000, v79
  v_rcp_f32 v79, v79
  s_or_b64 s[18:19], s[18:19], vcc
  s_nop 0
  v_mul_f32 v62, v62, v79
  v_mul_f32 v72, v72, v79
  v_min_f32 v52, v108, v36
  v_sub_f32 v64, v52, v108
  v_sub_f32 v74, v52, v36
  v_exp_f32 v64, v64
  v_exp_f32 v74, v74
  s_nop 0
  v_mul_f32 v80, v64, v128
  v_fmac_f32 v80, v74, v44
  s_nop 0
  v_cmp_nge_f32 vcc, 0x5f800000, v80
  v_rcp_f32 v80, v80
  s_or_b64 s[18:19], s[18:19], vcc
  s_nop 0
  v_mul_f32 v64, v64, v80
  v_mul_f32 v74, v74, v80
  s_cmp_lg_u64 s[18:19], 0
  s_cselect_b32 s72, 1, 0
  s_add_u32 s59, s52, 23552
  v_mov_b32 v30, s59
  v_mov_b32 v31, s72
  ds_write_b32 v30, v31
  v_add_u32 v26, s71, v2
  s_waitcnt lgkmcnt(0)
  v_accvgpr_read_b32 v84, a0
  v_accvgpr_read_b32 v85, a1
  v_accvgpr_read_b32 v86, a2
  v_accvgpr_read_b32 v87, a3
  v_accvgpr_read_b32 v88, a20
  v_accvgpr_read_b32 v89, a21
  v_accvgpr_read_b32 v90, a22
  v_accvgpr_read_b32 v91, a23
  v_pk_mul_f32 v[84:85], v[84:85], v[56:57] op_sel_hi:[1,0]
  v_pk_fma_f32 v[84:85], v[132:133], v[66:67], v[84:85] op_sel_hi:[1,0,1]
  v_pk_mul_f32 v[86:87], v[86:87], v[56:57] op_sel_hi:[1,0]
  v_pk_fma_f32 v[86:87], v[134:135], v[66:67], v[86:87] op_sel_hi:[1,0,1]
  v_pk_mul_f32 v[88:89], v[88:89], v[56:57] op_sel_hi:[1,0]
  v_pk_fma_f32 v[88:89], v[152:153], v[66:67], v[88:89] op_sel_hi:[1,0,1]
  v_pk_mul_f32 v[90:91], v[90:91], v[56:57] op_sel_hi:[1,0]
  v_pk_fma_f32 v[90:91], v[154:155], v[66:67], v[90:91] op_sel_hi:[1,0,1]
  v_cvt_pk_bf16_f32 v92, v84, v85
  v_cvt_pk_bf16_f32 v93, v86, v87
  v_cvt_pk_bf16_f32 v94, v88, v89
  v_cvt_pk_bf16_f32 v95, v90, v91
  ds_write_b128 v26, v[92:95] offset:0
  v_accvgpr_read_b32 v96, a4
  v_accvgpr_read_b32 v97, a5
  v_accvgpr_read_b32 v98, a6
  v_accvgpr_read_b32 v99, a7
  v_accvgpr_read_b32 v100, a24
  v_accvgpr_read_b32 v101, a25
  v_accvgpr_read_b32 v102, a26
  v_accvgpr_read_b32 v103, a27
  v_pk_mul_f32 v[96:97], v[96:97], v[58:59] op_sel_hi:[1,0]
  v_pk_fma_f32 v[96:97], v[136:137], v[68:69], v[96:97] op_sel_hi:[1,0,1]
  v_pk_mul_f32 v[98:99], v[98:99], v[58:59] op_sel_hi:[1,0]
  v_pk_fma_f32 v[98:99], v[138:139], v[68:69], v[98:99] op_sel_hi:[1,0,1]
  v_pk_mul_f32 v[100:101], v[100:101], v[58:59] op_sel_hi:[1,0]
  v_pk_fma_f32 v[100:101], v[156:157], v[68:69], v[100:101] op_sel_hi:[1,0,1]
  v_pk_mul_f32 v[102:103], v[102:103], v[58:59] op_sel_hi:[1,0]
  v_pk_fma_f32 v[102:103], v[158:159], v[68:69], v[102:103] op_sel_hi:[1,0,1]
  v_cvt_pk_bf16_f32 v104, v96, v97
  v_cvt_pk_bf16_f32 v105, v98, v99
  v_cvt_pk_bf16_f32 v106, v100, v101
  v_cvt_pk_bf16_f32 v107, v102, v103
  ds_write_b128 v26, v[104:107] offset:1024
  v_accvgpr_read_b32 v84, a8
  v_accvgpr_read_b32 v85, a9
  v_accvgpr_read_b32 v86, a10
  v_accvgpr_read_b32 v87, a11
  v_accvgpr_read_b32 v88, a28
  v_accvgpr_read_b32 v89, a29
  v_accvgpr_read_b32 v90, a30
  v_accvgpr_read_b32 v91, a31
  v_pk_mul_f32 v[84:85], v[84:85], v[60:61] op_sel_hi:[1,0]
  v_pk_fma_f32 v[84:85], v[140:141], v[70:71], v[84:85] op_sel_hi:[1,0,1]
  v_pk_mul_f32 v[86:87], v[86:87], v[60:61] op_sel_hi:[1,0]
  v_pk_fma_f32 v[86:87], v[142:143], v[70:71], v[86:87] op_sel_hi:[1,0,1]
  v_pk_mul_f32 v[88:89], v[88:89], v[60:61] op_sel_hi:[1,0]
  v_pk_fma_f32 v[88:89], v[160:161], v[70:71], v[88:89] op_sel_hi:[1,0,1]
  v_pk_mul_f32 v[90:91], v[90:91], v[60:61] op_sel_hi:[1,0]
  v_pk_fma_f32 v[90:91], v[162:163], v[70:71], v[90:91] op_sel_hi:[1,0,1]
  v_cvt_pk_bf16_f32 v92, v84, v85
  v_cvt_pk_bf16_f32 v93, v86, v87
  v_cvt_pk_bf16_f32 v94, v88, v89
  v_cvt_pk_bf16_f32 v95, v90, v91
  ds_write_b128 v26, v[92:95] offset:2048
  v_accvgpr_read_b32 v96, a12
  v_accvgpr_read_b32 v97, a13
  v_accvgpr_read_b32 v98, a14
  v_accvgpr_read_b32 v99, a15
  v_accvgpr_read_b32 v100, a32
  v_accvgpr_read_b32 v101, a33
  v_accvgpr_read_b32 v102, a34
  v_accvgpr_read_b32 v103, a35
  v_pk_mul_f32 v[96:97], v[96:97], v[62:63] op_sel_hi:[1,0]
  v_pk_fma_f32 v[96:97], v[144:145], v[72:73], v[96:97] op_sel_hi:[1,0,1]
  v_pk_mul_f32 v[98:99], v[98:99], v[62:63] op_sel_hi:[1,0]
  v_pk_fma_f32 v[98:99], v[146:147], v[72:73], v[98:99] op_sel_hi:[1,0,1]
  v_pk_mul_f32 v[100:101], v[100:101], v[62:63] op_sel_hi:[1,0]
  v_pk_fma_f32 v[100:101], v[164:165], v[72:73], v[100:101] op_sel_hi:[1,0,1]
  v_pk_mul_f32 v[102:103], v[102:103], v[62:63] op_sel_hi:[1,0]
  v_pk_fma_f32 v[102:103], v[166:167], v[72:73], v[102:103] op_sel_hi:[1,0,1]
  v_cvt_pk_bf16_f32 v104, v96, v97
  v_cvt_pk_bf16_f32 v105, v98, v99
  v_cvt_pk_bf16_f32 v106, v100, v101
  v_cvt_pk_bf16_f32 v107, v102, v103
  ds_write_b128 v26, v[104:107] offset:3072
  v_accvgpr_read_b32 v84, a16
  v_accvgpr_read_b32 v85, a17
  v_accvgpr_read_b32 v86, a18
  v_accvgpr_read_b32 v87, a19
  v_accvgpr_read_b32 v88, a36
  v_accvgpr_read_b32 v89, a37
  v_accvgpr_read_b32 v90, a38
  v_accvgpr_read_b32 v91, a39
  v_pk_mul_f32 v[84:85], v[84:85], v[64:65] op_sel_hi:[1,0]
  v_pk_fma_f32 v[84:85], v[148:149], v[74:75], v[84:85] op_sel_hi:[1,0,1]
  v_pk_mul_f32 v[86:87], v[86:87], v[64:65] op_sel_hi:[1,0]
  v_pk_fma_f32 v[86:87], v[150:151], v[74:75], v[86:87] op_sel_hi:[1,0,1]
  v_pk_mul_f32 v[88:89], v[88:89], v[64:65] op_sel_hi:[1,0]
  v_pk_fma_f32 v[88:89], v[168:169], v[74:75], v[88:89] op_sel_hi:[1,0,1]
  v_pk_mul_f32 v[90:91], v[90:91], v[64:65] op_sel_hi:[1,0]
  v_pk_fma_f32 v[90:91], v[170:171], v[74:75], v[90:91] op_sel_hi:[1,0,1]
  v_cvt_pk_bf16_f32 v92, v84, v85
  v_cvt_pk_bf16_f32 v93, v86, v87
  v_cvt_pk_bf16_f32 v94, v88, v89
  v_cvt_pk_bf16_f32 v95, v90, v91
  ds_write_b128 v26, v[92:95] offset:4096
  v_accvgpr_read_b32 v96, a40
  v_accvgpr_read_b32 v97, a41
  v_accvgpr_read_b32 v98, a42
  v_accvgpr_read_b32 v99, a43
  v_accvgpr_read_b32 v100, a60
  v_accvgpr_read_b32 v101, a61
  v_accvgpr_read_b32 v102, a62
  v_accvgpr_read_b32 v103, a63
  v_pk_mul_f32 v[96:97], v[96:97], v[56:57] op_sel_hi:[1,0]
  v_pk_fma_f32 v[96:97], v[172:173], v[66:67], v[96:97] op_sel_hi:[1,0,1]
  v_pk_mul_f32 v[98:99], v[98:99], v[56:57] op_sel_hi:[1,0]
  v_pk_fma_f32 v[98:99], v[174:175], v[66:67], v[98:99] op_sel_hi:[1,0,1]
  v_pk_mul_f32 v[100:101], v[100:101], v[56:57] op_sel_hi:[1,0]
  v_pk_fma_f32 v[100:101], v[192:193], v[66:67], v[100:101] op_sel_hi:[1,0,1]
  v_pk_mul_f32 v[102:103], v[102:103], v[56:57] op_sel_hi:[1,0]
  v_pk_fma_f32 v[102:103], v[194:195], v[66:67], v[102:103] op_sel_hi:[1,0,1]
  v_cvt_pk_bf16_f32 v104, v96, v97
  v_cvt_pk_bf16_f32 v105, v98, v99
  v_cvt_pk_bf16_f32 v106, v100, v101
  v_cvt_pk_bf16_f32 v107, v102, v103
  ds_write_b128 v26, v[104:107] offset:5120
  v_accvgpr_read_b32 v84, a44
  v_accvgpr_read_b32 v85, a45
  v_accvgpr_read_b32 v86, a46
  v_accvgpr_read_b32 v87, a47
  v_accvgpr_read_b32 v88, a64
  v_accvgpr_read_b32 v89, a65
  v_accvgpr_read_b32 v90, a66
  v_accvgpr_read_b32 v91, a67
  v_pk_mul_f32 v[84:85], v[84:85], v[58:59] op_sel_hi:[1,0]
  v_pk_fma_f32 v[84:85], v[176:177], v[68:69], v[84:85] op_sel_hi:[1,0,1]
  v_pk_mul_f32 v[86:87], v[86:87], v[58:59] op_sel_hi:[1,0]
  v_pk_fma_f32 v[86:87], v[178:179], v[68:69], v[86:87] op_sel_hi:[1,0,1]
  v_pk_mul_f32 v[88:89], v[88:89], v[58:59] op_sel_hi:[1,0]
  v_pk_fma_f32 v[88:89], v[196:197], v[68:69], v[88:89] op_sel_hi:[1,0,1]
  v_pk_mul_f32 v[90:91], v[90:91], v[58:59] op_sel_hi:[1,0]
  v_pk_fma_f32 v[90:91], v[198:199], v[68:69], v[90:91] op_sel_hi:[1,0,1]
  v_cvt_pk_bf16_f32 v92, v84, v85
  v_cvt_pk_bf16_f32 v93, v86, v87
  v_cvt_pk_bf16_f32 v94, v88, v89
  v_cvt_pk_bf16_f32 v95, v90, v91
  ds_write_b128 v26, v[92:95] offset:6144
  v_accvgpr_read_b32 v96, a48
  v_accvgpr_read_b32 v97, a49
  v_accvgpr_read_b32 v98, a50
  v_accvgpr_read_b32 v99, a51
  v_accvgpr_read_b32 v100, a68
  v_accvgpr_read_b32 v101, a69
  v_accvgpr_read_b32 v102, a70
  v_accvgpr_read_b32 v103, a71
  v_pk_mul_f32 v[96:97], v[96:97], v[60:61] op_sel_hi:[1,0]
  v_pk_fma_f32 v[96:97], v[180:181], v[70:71], v[96:97] op_sel_hi:[1,0,1]
  v_pk_mul_f32 v[98:99], v[98:99], v[60:61] op_sel_hi:[1,0]
  v_pk_fma_f32 v[98:99], v[182:183], v[70:71], v[98:99] op_sel_hi:[1,0,1]
  v_pk_mul_f32 v[100:101], v[100:101], v[60:61] op_sel_hi:[1,0]
  v_pk_fma_f32 v[100:101], v[200:201], v[70:71], v[100:101] op_sel_hi:[1,0,1]
  v_pk_mul_f32 v[102:103], v[102:103], v[60:61] op_sel_hi:[1,0]
  v_pk_fma_f32 v[102:103], v[202:203], v[70:71], v[102:103] op_sel_hi:[1,0,1]
  v_cvt_pk_bf16_f32 v104, v96, v97
  v_cvt_pk_bf16_f32 v105, v98, v99
  v_cvt_pk_bf16_f32 v106, v100, v101
  v_cvt_pk_bf16_f32 v107, v102, v103
  ds_write_b128 v26, v[104:107] offset:7168
  v_accvgpr_read_b32 v84, a52
  v_accvgpr_read_b32 v85, a53
  v_accvgpr_read_b32 v86, a54
  v_accvgpr_read_b32 v87, a55
  v_accvgpr_read_b32 v88, a72
  v_accvgpr_read_b32 v89, a73
  v_accvgpr_read_b32 v90, a74
  v_accvgpr_read_b32 v91, a75
  v_pk_mul_f32 v[84:85], v[84:85], v[62:63] op_sel_hi:[1,0]
  v_pk_fma_f32 v[84:85], v[184:185], v[72:73], v[84:85] op_sel_hi:[1,0,1]
  v_pk_mul_f32 v[86:87], v[86:87], v[62:63] op_sel_hi:[1,0]
  v_pk_fma_f32 v[86:87], v[186:187], v[72:73], v[86:87] op_sel_hi:[1,0,1]
  v_pk_mul_f32 v[88:89], v[88:89], v[62:63] op_sel_hi:[1,0]
  v_pk_fma_f32 v[88:89], v[204:205], v[72:73], v[88:89] op_sel_hi:[1,0,1]
  v_pk_mul_f32 v[90:91], v[90:91], v[62:63] op_sel_hi:[1,0]
  v_pk_fma_f32 v[90:91], v[206:207], v[72:73], v[90:91] op_sel_hi:[1,0,1]
  v_cvt_pk_bf16_f32 v92, v84, v85
  v_cvt_pk_bf16_f32 v93, v86, v87
  v_cvt_pk_bf16_f32 v94, v88, v89
  v_cvt_pk_bf16_f32 v95, v90, v91
  ds_write_b128 v26, v[92:95] offset:8192
  v_accvgpr_read_b32 v96, a56
  v_accvgpr_read_b32 v97, a57
  v_accvgpr_read_b32 v98, a58
  v_accvgpr_read_b32 v99, a59
  v_accvgpr_read_b32 v100, a76
  v_accvgpr_read_b32 v101, a77
  v_accvgpr_read_b32 v102, a78
  v_accvgpr_read_b32 v103, a79
  v_pk_mul_f32 v[96:97], v[96:97], v[64:65] op_sel_hi:[1,0]
  v_pk_fma_f32 v[96:97], v[188:189], v[74:75], v[96:97] op_sel_hi:[1,0,1]
  v_pk_mul_f32 v[98:99], v[98:99], v[64:65] op_sel_hi:[1,0]
  v_pk_fma_f32 v[98:99], v[190:191], v[74:75], v[98:99] op_sel_hi:[1,0,1]
  v_pk_mul_f32 v[100:101], v[100:101], v[64:65] op_sel_hi:[1,0]
  v_pk_fma_f32 v[100:101], v[208:209], v[74:75], v[100:101] op_sel_hi:[1,0,1]
  v_pk_mul_f32 v[102:103], v[102:103], v[64:65] op_sel_hi:[1,0]
  v_pk_fma_f32 v[102:103], v[210:211], v[74:75], v[102:103] op_sel_hi:[1,0,1]
  v_cvt_pk_bf16_f32 v104, v96, v97
  v_cvt_pk_bf16_f32 v105, v98, v99
  v_cvt_pk_bf16_f32 v106, v100, v101
  v_cvt_pk_bf16_f32 v107, v102, v103
  ds_write_b128 v26, v[104:107] offset:9216
  v_lshrrev_b32 v30, 2, v23
  v_lshlrev_b32 v31, 2, v22
  v_add_u32 v30, v30, v31
  v_and_b32 v31, 7, v30
  v_lshlrev_b32 v31, 1, v31
  v_bfe_u32 v28, v23, 1, 1
  v_xor_b32 v31, v31, v28
  s_lshl_b32 s59, s27, 3
  v_xor_b32 v31, s59, v31
  v_lshlrev_b32 v30, 8, v30
  v_and_b32 v28, 1, v23
  v_lshlrev_b32 v28, 3, v28
  v_add_u32 v30, v30, v28
  s_add_u32 s60, s52, 0
  v_add_u32 v30, s60, v30
  v_xor_b32 v28, 0, v31
  v_lshlrev_b32 v28, 4, v28
  v_add_u32 v8, v30, v28
  v_xor_b32 v28, 2, v31
  v_lshlrev_b32 v28, 4, v28
  v_add_u32 v9, v30, v28
  v_xor_b32 v28, 4, v31
  v_lshlrev_b32 v28, 4, v28
  v_add_u32 v10, v30, v28
  v_xor_b32 v28, 6, v31
  v_lshlrev_b32 v28, 4, v28
  v_add_u32 v11, v30, v28
  v_xor_b32 v28, 8, v31
  v_lshlrev_b32 v28, 4, v28
  v_add_u32 v12, v30, v28
  v_xor_b32 v28, 10, v31
  v_lshlrev_b32 v28, 4, v28
  v_add_u32 v13, v30, v28
  v_xor_b32 v28, 12, v31
  v_lshlrev_b32 v28, 4, v28
  v_add_u32 v14, v30, v28
  v_xor_b32 v28, 14, v31
  v_lshlrev_b32 v28, 4, v28
  v_add_u32 v15, v30, v28
  v_mov_b32 v6, v2
  v_add_u32 v7, 81920, v2
  s_waitcnt lgkmcnt(0)
  s_barrier
  s_add_u32 m0, s52, 12288
  s_mov_b32 s60, 65536
  buffer_load_dwordx4 v4, s[80:83], s60 offen  lds
  buffer_load_dwordx4 v5, s[80:83], s60 offen offset:1024  lds
  buffer_load_dwordx4 v24, s[80:83], s60 offen offset:2048  lds
  buffer_load_dwordx4 v25, s[80:83], s60 offen offset:3072  lds
  s_add_u32 m0, s52, 16384
  s_mov_b32 s60, 81920
  buffer_load_dwordx4 v4, s[80:83], s60 offen  lds
  buffer_load_dwordx4 v5, s[80:83], s60 offen offset:1024  lds
  buffer_load_dwordx4 v24, s[80:83], s60 offen offset:2048  lds
  buffer_load_dwordx4 v25, s[80:83], s60 offen offset:3072  lds
  v_and_b32 v30, 3, v1
  v_mul_u32_u24 v30, 40960, v30
  ds_read_b32 v31, v30 offset:23552
  s_waitcnt vmcnt(16)
  ds_read_b128 a[64:67], v6 offset:40960
  ds_read_b128 a[68:71], v6 offset:41984
  ds_read_b128 a[72:75], v6 offset:43008
  ds_read_b128 a[76:79], v6 offset:44032
  ds_read_b128 a[80:83], v6 offset:45056
  ds_read_b64_tr_b16 a[0:1], v8 offset:24576
  ds_read_b64_tr_b16 a[2:3], v8 offset:28672
  ds_read_b64_tr_b16 a[4:5], v9 offset:24576
  ds_read_b64_tr_b16 a[6:7], v9 offset:28672
  ds_read_b64_tr_b16 a[8:9], v10 offset:24576
  ds_read_b64_tr_b16 a[10:11], v10 offset:28672
  ds_read_b64_tr_b16 a[12:13], v11 offset:24576
  ds_read_b64_tr_b16 a[14:15], v11 offset:28672
  ds_read_b64_tr_b16 a[16:17], v12 offset:24576
  ds_read_b64_tr_b16 a[18:19], v12 offset:28672
  ds_read_b64_tr_b16 a[20:21], v13 offset:24576
  ds_read_b64_tr_b16 a[22:23], v13 offset:28672
  ds_read_b64_tr_b16 a[24:25], v14 offset:24576
  ds_read_b64_tr_b16 a[26:27], v14 offset:28672
  ds_read_b64_tr_b16 a[28:29], v15 offset:24576
  ds_read_b64_tr_b16 a[30:31], v15 offset:28672
  s_waitcnt lgkmcnt(0)
  v_cmp_ne_u32 vcc, 0, v31
  s_cmp_eq_u32 s16, 0
  s_cselect_b64 s[20:21], vcc, 0
  s_cmp_lg_u64 s[20:21], 0
  s_cbranch_scc1 concat_heads__gqa_block_cached__mha_block_cached__near_ridge_kernel_fallback
  v_mfma_f32_16x16x32_bf16 v[96:99], a[0:3], a[64:67], 0
  s_waitcnt vmcnt(8)
  v_mfma_f32_16x16x32_bf16 v[100:103], a[0:3], a[68:71], 0
  ds_read_b128 a[84:87], v6 offset:46080
  v_mfma_f32_16x16x32_bf16 v[104:107], a[0:3], a[72:75], 0
  ds_read_b128 a[88:91], v6 offset:47104
  v_mfma_f32_16x16x32_bf16 v[108:111], a[0:3], a[76:79], 0
  ds_read_b128 a[92:95], v6 offset:48128
  v_mfma_f32_16x16x32_bf16 v[112:115], a[0:3], a[80:83], 0
  ds_read_b128 a[96:99], v6 offset:49152
  v_mfma_f32_16x16x32_bf16 v[116:119], a[4:7], a[64:67], 0
  ds_read_b128 a[100:103], v6 offset:50176
  v_mfma_f32_16x16x32_bf16 v[120:123], a[4:7], a[68:71], 0
  ds_read_b64_tr_b16 a[32:33], v8 offset:32768
  v_mfma_f32_16x16x32_bf16 v[124:127], a[4:7], a[72:75], 0
  ds_read_b64_tr_b16 a[34:35], v8 offset:36864
  v_mfma_f32_16x16x32_bf16 v[128:131], a[4:7], a[76:79], 0
  ds_read_b64_tr_b16 a[36:37], v9 offset:32768
  v_mfma_f32_16x16x32_bf16 v[132:135], a[4:7], a[80:83], 0
  ds_read_b64_tr_b16 a[38:39], v9 offset:36864
  v_mfma_f32_16x16x32_bf16 v[136:139], a[8:11], a[64:67], 0
  ds_read_b64_tr_b16 a[40:41], v10 offset:32768
  v_mfma_f32_16x16x32_bf16 v[140:143], a[8:11], a[68:71], 0
  ds_read_b64_tr_b16 a[42:43], v10 offset:36864
  v_mfma_f32_16x16x32_bf16 v[144:147], a[8:11], a[72:75], 0
  ds_read_b64_tr_b16 a[44:45], v11 offset:32768
  v_mfma_f32_16x16x32_bf16 v[148:151], a[8:11], a[76:79], 0
  ds_read_b64_tr_b16 a[46:47], v11 offset:36864
  v_mfma_f32_16x16x32_bf16 v[152:155], a[8:11], a[80:83], 0
  ds_read_b64_tr_b16 a[48:49], v12 offset:32768
  v_mfma_f32_16x16x32_bf16 v[156:159], a[12:15], a[64:67], 0
  ds_read_b64_tr_b16 a[50:51], v12 offset:36864
  v_mfma_f32_16x16x32_bf16 v[160:163], a[12:15], a[68:71], 0
  ds_read_b64_tr_b16 a[52:53], v13 offset:32768
  s_add_u32 m0, s52, 24576
  v_mfma_f32_16x16x32_bf16 v[164:167], a[12:15], a[72:75], 0
  ds_read_b64_tr_b16 a[54:55], v13 offset:36864
  v_mfma_f32_16x16x32_bf16 v[168:171], a[12:15], a[76:79], 0
  ds_read_b64_tr_b16 a[56:57], v14 offset:32768
  s_mov_b32 s60, 98304
  v_mfma_f32_16x16x32_bf16 v[172:175], a[12:15], a[80:83], 0
  ds_read_b64_tr_b16 a[58:59], v14 offset:36864
  v_mfma_f32_16x16x32_bf16 v[176:179], a[16:19], a[64:67], 0
  ds_read_b64_tr_b16 a[60:61], v15 offset:32768
  buffer_load_dwordx4 v4, s[80:83], s60 offen  lds
  v_mfma_f32_16x16x32_bf16 v[180:183], a[16:19], a[68:71], 0
  ds_read_b64_tr_b16 a[62:63], v15 offset:36864
  v_mfma_f32_16x16x32_bf16 v[184:187], a[16:19], a[72:75], 0
  buffer_load_dwordx4 v5, s[80:83], s60 offen offset:1024  lds
  v_mfma_f32_16x16x32_bf16 v[188:191], a[16:19], a[76:79], 0
  v_mfma_f32_16x16x32_bf16 v[192:195], a[16:19], a[80:83], 0
  buffer_load_dwordx4 v24, s[80:83], s60 offen offset:2048  lds
  v_mfma_f32_16x16x32_bf16 v[196:199], a[20:23], a[64:67], 0
  v_mfma_f32_16x16x32_bf16 v[200:203], a[20:23], a[68:71], 0
  buffer_load_dwordx4 v25, s[80:83], s60 offen offset:3072  lds
  v_mfma_f32_16x16x32_bf16 v[204:207], a[20:23], a[72:75], 0
  v_mfma_f32_16x16x32_bf16 v[208:211], a[20:23], a[76:79], 0
  s_add_u32 m0, s52, 28672
  v_mfma_f32_16x16x32_bf16 v[212:215], a[20:23], a[80:83], 0
  v_mfma_f32_16x16x32_bf16 v[216:219], a[24:27], a[64:67], 0
  s_mov_b32 s60, 114688
  v_mfma_f32_16x16x32_bf16 v[220:223], a[24:27], a[68:71], 0
  v_mfma_f32_16x16x32_bf16 v[224:227], a[24:27], a[72:75], 0
  buffer_load_dwordx4 v4, s[80:83], s60 offen  lds
  v_mfma_f32_16x16x32_bf16 v[228:231], a[24:27], a[76:79], 0
  v_mfma_f32_16x16x32_bf16 v[232:235], a[24:27], a[80:83], 0
  buffer_load_dwordx4 v5, s[80:83], s60 offen offset:1024  lds
  v_mfma_f32_16x16x32_bf16 v[236:239], a[28:31], a[64:67], 0
  v_mfma_f32_16x16x32_bf16 v[240:243], a[28:31], a[68:71], 0
  buffer_load_dwordx4 v24, s[80:83], s60 offen offset:2048  lds
  v_mfma_f32_16x16x32_bf16 v[244:247], a[28:31], a[72:75], 0
  v_mfma_f32_16x16x32_bf16 v[248:251], a[28:31], a[76:79], 0
  buffer_load_dwordx4 v25, s[80:83], s60 offen offset:3072  lds
  v_mfma_f32_16x16x32_bf16 v[252:255], a[28:31], a[80:83], 0
  s_waitcnt lgkmcnt(0)
  v_mfma_f32_16x16x32_bf16 v[96:99], a[32:35], a[84:87], v[96:99]
  s_waitcnt vmcnt(8)
  v_mfma_f32_16x16x32_bf16 v[100:103], a[32:35], a[88:91], v[100:103]
  ds_read_b128 a[64:67], v6 offset:0
  v_mfma_f32_16x16x32_bf16 v[104:107], a[32:35], a[92:95], v[104:107]
  ds_read_b128 a[68:71], v6 offset:1024
  v_mfma_f32_16x16x32_bf16 v[108:111], a[32:35], a[96:99], v[108:111]
  ds_read_b128 a[72:75], v6 offset:2048
  v_mfma_f32_16x16x32_bf16 v[112:115], a[32:35], a[100:103], v[112:115]
  ds_read_b128 a[76:79], v6 offset:3072
  v_mfma_f32_16x16x32_bf16 v[116:119], a[36:39], a[84:87], v[116:119]
  ds_read_b128 a[80:83], v6 offset:4096
  v_mfma_f32_16x16x32_bf16 v[120:123], a[36:39], a[88:91], v[120:123]
  ds_read_b64_tr_b16 a[0:1], v8 offset:12288
  v_mfma_f32_16x16x32_bf16 v[124:127], a[36:39], a[92:95], v[124:127]
  ds_read_b64_tr_b16 a[2:3], v8 offset:16384
  v_mfma_f32_16x16x32_bf16 v[128:131], a[36:39], a[96:99], v[128:131]
  ds_read_b64_tr_b16 a[4:5], v9 offset:12288
  v_mfma_f32_16x16x32_bf16 v[132:135], a[36:39], a[100:103], v[132:135]
  ds_read_b64_tr_b16 a[6:7], v9 offset:16384
  v_mfma_f32_16x16x32_bf16 v[136:139], a[40:43], a[84:87], v[136:139]
  ds_read_b64_tr_b16 a[8:9], v10 offset:12288
  v_mfma_f32_16x16x32_bf16 v[140:143], a[40:43], a[88:91], v[140:143]
  ds_read_b64_tr_b16 a[10:11], v10 offset:16384
  v_mfma_f32_16x16x32_bf16 v[144:147], a[40:43], a[92:95], v[144:147]
  ds_read_b64_tr_b16 a[12:13], v11 offset:12288
  v_mfma_f32_16x16x32_bf16 v[148:151], a[40:43], a[96:99], v[148:151]
  ds_read_b64_tr_b16 a[14:15], v11 offset:16384
  v_mfma_f32_16x16x32_bf16 v[152:155], a[40:43], a[100:103], v[152:155]
  ds_read_b64_tr_b16 a[16:17], v12 offset:12288
  v_mfma_f32_16x16x32_bf16 v[156:159], a[44:47], a[84:87], v[156:159]
  ds_read_b64_tr_b16 a[18:19], v12 offset:16384
  v_mfma_f32_16x16x32_bf16 v[160:163], a[44:47], a[88:91], v[160:163]
  ds_read_b64_tr_b16 a[20:21], v13 offset:12288
  s_add_u32 m0, s52, 32768
  v_mfma_f32_16x16x32_bf16 v[164:167], a[44:47], a[92:95], v[164:167]
  ds_read_b64_tr_b16 a[22:23], v13 offset:16384
  v_mfma_f32_16x16x32_bf16 v[168:171], a[44:47], a[96:99], v[168:171]
  ds_read_b64_tr_b16 a[24:25], v14 offset:12288
  s_mov_b32 s60, 131072
  v_mfma_f32_16x16x32_bf16 v[172:175], a[44:47], a[100:103], v[172:175]
  ds_read_b64_tr_b16 a[26:27], v14 offset:16384
  v_mfma_f32_16x16x32_bf16 v[176:179], a[48:51], a[84:87], v[176:179]
  ds_read_b64_tr_b16 a[28:29], v15 offset:12288
  buffer_load_dwordx4 v4, s[80:83], s60 offen  lds
  v_mfma_f32_16x16x32_bf16 v[180:183], a[48:51], a[88:91], v[180:183]
  ds_read_b64_tr_b16 a[30:31], v15 offset:16384
  v_mfma_f32_16x16x32_bf16 v[184:187], a[48:51], a[92:95], v[184:187]
  buffer_load_dwordx4 v5, s[80:83], s60 offen offset:1024  lds
  v_mfma_f32_16x16x32_bf16 v[188:191], a[48:51], a[96:99], v[188:191]
  v_mfma_f32_16x16x32_bf16 v[192:195], a[48:51], a[100:103], v[192:195]
  buffer_load_dwordx4 v24, s[80:83], s60 offen offset:2048  lds
  v_mfma_f32_16x16x32_bf16 v[196:199], a[52:55], a[84:87], v[196:199]
  v_mfma_f32_16x16x32_bf16 v[200:203], a[52:55], a[88:91], v[200:203]
  buffer_load_dwordx4 v25, s[80:83], s60 offen offset:3072  lds
  v_mfma_f32_16x16x32_bf16 v[204:207], a[52:55], a[92:95], v[204:207]
  v_mfma_f32_16x16x32_bf16 v[208:211], a[52:55], a[96:99], v[208:211]
  s_add_u32 m0, s52, 36864
  v_mfma_f32_16x16x32_bf16 v[212:215], a[52:55], a[100:103], v[212:215]
  v_mfma_f32_16x16x32_bf16 v[216:219], a[56:59], a[84:87], v[216:219]
  s_mov_b32 s60, 147456
  v_mfma_f32_16x16x32_bf16 v[220:223], a[56:59], a[88:91], v[220:223]
  v_mfma_f32_16x16x32_bf16 v[224:227], a[56:59], a[92:95], v[224:227]
  buffer_load_dwordx4 v4, s[80:83], s60 offen  lds
  v_mfma_f32_16x16x32_bf16 v[228:231], a[56:59], a[96:99], v[228:231]
  v_mfma_f32_16x16x32_bf16 v[232:235], a[56:59], a[100:103], v[232:235]
  buffer_load_dwordx4 v5, s[80:83], s60 offen offset:1024  lds
  v_mfma_f32_16x16x32_bf16 v[236:239], a[60:63], a[84:87], v[236:239]
  v_mfma_f32_16x16x32_bf16 v[240:243], a[60:63], a[88:91], v[240:243]
  buffer_load_dwordx4 v24, s[80:83], s60 offen offset:2048  lds
  v_mfma_f32_16x16x32_bf16 v[244:247], a[60:63], a[92:95], v[244:247]
  v_mfma_f32_16x16x32_bf16 v[248:251], a[60:63], a[96:99], v[248:251]
  buffer_load_dwordx4 v25, s[80:83], s60 offen offset:3072  lds
  v_mfma_f32_16x16x32_bf16 v[252:255], a[60:63], a[100:103], v[252:255]
  s_waitcnt lgkmcnt(0)
  v_mfma_f32_16x16x32_bf16 v[96:99], a[0:3], a[64:67], v[96:99]
  s_waitcnt vmcnt(8)
  v_mfma_f32_16x16x32_bf16 v[100:103], a[0:3], a[68:71], v[100:103]
  ds_read_b128 a[84:87], v6 offset:5120
  v_mfma_f32_16x16x32_bf16 v[104:107], a[0:3], a[72:75], v[104:107]
  ds_read_b128 a[88:91], v6 offset:6144
  v_mfma_f32_16x16x32_bf16 v[108:111], a[0:3], a[76:79], v[108:111]
  ds_read_b128 a[92:95], v6 offset:7168
  v_mfma_f32_16x16x32_bf16 v[112:115], a[0:3], a[80:83], v[112:115]
  ds_read_b128 a[96:99], v6 offset:8192
  v_mfma_f32_16x16x32_bf16 v[116:119], a[4:7], a[64:67], v[116:119]
  ds_read_b128 a[100:103], v6 offset:9216
  v_mfma_f32_16x16x32_bf16 v[120:123], a[4:7], a[68:71], v[120:123]
  ds_read_b64_tr_b16 a[32:33], v8 offset:24576
  v_mfma_f32_16x16x32_bf16 v[124:127], a[4:7], a[72:75], v[124:127]
  ds_read_b64_tr_b16 a[34:35], v8 offset:28672
  v_mfma_f32_16x16x32_bf16 v[128:131], a[4:7], a[76:79], v[128:131]
  ds_read_b64_tr_b16 a[36:37], v9 offset:24576
  v_mfma_f32_16x16x32_bf16 v[132:135], a[4:7], a[80:83], v[132:135]
  ds_read_b64_tr_b16 a[38:39], v9 offset:28672
  v_mfma_f32_16x16x32_bf16 v[136:139], a[8:11], a[64:67], v[136:139]
  ds_read_b64_tr_b16 a[40:41], v10 offset:24576
  v_mfma_f32_16x16x32_bf16 v[140:143], a[8:11], a[68:71], v[140:143]
  ds_read_b64_tr_b16 a[42:43], v10 offset:28672
  v_mfma_f32_16x16x32_bf16 v[144:147], a[8:11], a[72:75], v[144:147]
  ds_read_b64_tr_b16 a[44:45], v11 offset:24576
  v_mfma_f32_16x16x32_bf16 v[148:151], a[8:11], a[76:79], v[148:151]
  ds_read_b64_tr_b16 a[46:47], v11 offset:28672
  v_mfma_f32_16x16x32_bf16 v[152:155], a[8:11], a[80:83], v[152:155]
  ds_read_b64_tr_b16 a[48:49], v12 offset:24576
  v_mfma_f32_16x16x32_bf16 v[156:159], a[12:15], a[64:67], v[156:159]
  ds_read_b64_tr_b16 a[50:51], v12 offset:28672
  v_mfma_f32_16x16x32_bf16 v[160:163], a[12:15], a[68:71], v[160:163]
  ds_read_b64_tr_b16 a[52:53], v13 offset:24576
  s_add_u32 m0, s52, 12288
  v_mfma_f32_16x16x32_bf16 v[164:167], a[12:15], a[72:75], v[164:167]
  ds_read_b64_tr_b16 a[54:55], v13 offset:28672
  v_mfma_f32_16x16x32_bf16 v[168:171], a[12:15], a[76:79], v[168:171]
  ds_read_b64_tr_b16 a[56:57], v14 offset:24576
  s_mov_b32 s60, 163840
  v_mfma_f32_16x16x32_bf16 v[172:175], a[12:15], a[80:83], v[172:175]
  ds_read_b64_tr_b16 a[58:59], v14 offset:28672
  v_mfma_f32_16x16x32_bf16 v[176:179], a[16:19], a[64:67], v[176:179]
  ds_read_b64_tr_b16 a[60:61], v15 offset:24576
  buffer_load_dwordx4 v4, s[80:83], s60 offen  lds
  v_mfma_f32_16x16x32_bf16 v[180:183], a[16:19], a[68:71], v[180:183]
  ds_read_b64_tr_b16 a[62:63], v15 offset:28672
  v_mfma_f32_16x16x32_bf16 v[184:187], a[16:19], a[72:75], v[184:187]
  buffer_load_dwordx4 v5, s[80:83], s60 offen offset:1024  lds
  v_mfma_f32_16x16x32_bf16 v[188:191], a[16:19], a[76:79], v[188:191]
  v_mfma_f32_16x16x32_bf16 v[192:195], a[16:19], a[80:83], v[192:195]
  buffer_load_dwordx4 v24, s[80:83], s60 offen offset:2048  lds
  v_mfma_f32_16x16x32_bf16 v[196:199], a[20:23], a[64:67], v[196:199]
  v_mfma_f32_16x16x32_bf16 v[200:203], a[20:23], a[68:71], v[200:203]
  buffer_load_dwordx4 v25, s[80:83], s60 offen offset:3072  lds
  v_mfma_f32_16x16x32_bf16 v[204:207], a[20:23], a[72:75], v[204:207]
  v_mfma_f32_16x16x32_bf16 v[208:211], a[20:23], a[76:79], v[208:211]
  s_add_u32 m0, s52, 16384
  v_mfma_f32_16x16x32_bf16 v[212:215], a[20:23], a[80:83], v[212:215]
  v_mfma_f32_16x16x32_bf16 v[216:219], a[24:27], a[64:67], v[216:219]
  s_mov_b32 s60, 180224
  v_mfma_f32_16x16x32_bf16 v[220:223], a[24:27], a[68:71], v[220:223]
  v_mfma_f32_16x16x32_bf16 v[224:227], a[24:27], a[72:75], v[224:227]
  buffer_load_dwordx4 v4, s[80:83], s60 offen  lds
  v_mfma_f32_16x16x32_bf16 v[228:231], a[24:27], a[76:79], v[228:231]
  v_mfma_f32_16x16x32_bf16 v[232:235], a[24:27], a[80:83], v[232:235]
  buffer_load_dwordx4 v5, s[80:83], s60 offen offset:1024  lds
  v_mfma_f32_16x16x32_bf16 v[236:239], a[28:31], a[64:67], v[236:239]
  v_mfma_f32_16x16x32_bf16 v[240:243], a[28:31], a[68:71], v[240:243]
  buffer_load_dwordx4 v24, s[80:83], s60 offen offset:2048  lds
  v_mfma_f32_16x16x32_bf16 v[244:247], a[28:31], a[72:75], v[244:247]
  v_mfma_f32_16x16x32_bf16 v[248:251], a[28:31], a[76:79], v[248:251]
  buffer_load_dwordx4 v25, s[80:83], s60 offen offset:3072  lds
  v_mfma_f32_16x16x32_bf16 v[252:255], a[28:31], a[80:83], v[252:255]
  s_waitcnt lgkmcnt(0)
  v_mfma_f32_16x16x32_bf16 v[96:99], a[32:35], a[84:87], v[96:99]
  s_waitcnt vmcnt(8)
  v_mfma_f32_16x16x32_bf16 v[100:103], a[32:35], a[88:91], v[100:103]
  ds_read_b128 a[64:67], v7 offset:40960
  v_mfma_f32_16x16x32_bf16 v[104:107], a[32:35], a[92:95], v[104:107]
  ds_read_b128 a[68:71], v7 offset:41984
  v_mfma_f32_16x16x32_bf16 v[108:111], a[32:35], a[96:99], v[108:111]
  ds_read_b128 a[72:75], v7 offset:43008
  v_mfma_f32_16x16x32_bf16 v[112:115], a[32:35], a[100:103], v[112:115]
  ds_read_b128 a[76:79], v7 offset:44032
  v_mfma_f32_16x16x32_bf16 v[116:119], a[36:39], a[84:87], v[116:119]
  ds_read_b128 a[80:83], v7 offset:45056
  v_mfma_f32_16x16x32_bf16 v[120:123], a[36:39], a[88:91], v[120:123]
  ds_read_b64_tr_b16 a[0:1], v8 offset:32768
  v_mfma_f32_16x16x32_bf16 v[124:127], a[36:39], a[92:95], v[124:127]
  ds_read_b64_tr_b16 a[2:3], v8 offset:36864
  v_mfma_f32_16x16x32_bf16 v[128:131], a[36:39], a[96:99], v[128:131]
  ds_read_b64_tr_b16 a[4:5], v9 offset:32768
  v_mfma_f32_16x16x32_bf16 v[132:135], a[36:39], a[100:103], v[132:135]
  ds_read_b64_tr_b16 a[6:7], v9 offset:36864
  v_mfma_f32_16x16x32_bf16 v[136:139], a[40:43], a[84:87], v[136:139]
  ds_read_b64_tr_b16 a[8:9], v10 offset:32768
  v_mfma_f32_16x16x32_bf16 v[140:143], a[40:43], a[88:91], v[140:143]
  ds_read_b64_tr_b16 a[10:11], v10 offset:36864
  v_mfma_f32_16x16x32_bf16 v[144:147], a[40:43], a[92:95], v[144:147]
  ds_read_b64_tr_b16 a[12:13], v11 offset:32768
  v_mfma_f32_16x16x32_bf16 v[148:151], a[40:43], a[96:99], v[148:151]
  ds_read_b64_tr_b16 a[14:15], v11 offset:36864
  v_mfma_f32_16x16x32_bf16 v[152:155], a[40:43], a[100:103], v[152:155]
  ds_read_b64_tr_b16 a[16:17], v12 offset:32768
  v_mfma_f32_16x16x32_bf16 v[156:159], a[44:47], a[84:87], v[156:159]
  ds_read_b64_tr_b16 a[18:19], v12 offset:36864
  v_mfma_f32_16x16x32_bf16 v[160:163], a[44:47], a[88:91], v[160:163]
  ds_read_b64_tr_b16 a[20:21], v13 offset:32768
  s_add_u32 m0, s52, 24576
  v_mfma_f32_16x16x32_bf16 v[164:167], a[44:47], a[92:95], v[164:167]
  ds_read_b64_tr_b16 a[22:23], v13 offset:36864
  v_mfma_f32_16x16x32_bf16 v[168:171], a[44:47], a[96:99], v[168:171]
  ds_read_b64_tr_b16 a[24:25], v14 offset:32768
  s_mov_b32 s60, 196608
  v_mfma_f32_16x16x32_bf16 v[172:175], a[44:47], a[100:103], v[172:175]
  ds_read_b64_tr_b16 a[26:27], v14 offset:36864
  v_mfma_f32_16x16x32_bf16 v[176:179], a[48:51], a[84:87], v[176:179]
  ds_read_b64_tr_b16 a[28:29], v15 offset:32768
  buffer_load_dwordx4 v4, s[80:83], s60 offen  lds
  v_mfma_f32_16x16x32_bf16 v[180:183], a[48:51], a[88:91], v[180:183]
  ds_read_b64_tr_b16 a[30:31], v15 offset:36864
  v_mfma_f32_16x16x32_bf16 v[184:187], a[48:51], a[92:95], v[184:187]
  buffer_load_dwordx4 v5, s[80:83], s60 offen offset:1024  lds
  v_mfma_f32_16x16x32_bf16 v[188:191], a[48:51], a[96:99], v[188:191]
  v_mfma_f32_16x16x32_bf16 v[192:195], a[48:51], a[100:103], v[192:195]
  buffer_load_dwordx4 v24, s[80:83], s60 offen offset:2048  lds
  v_mfma_f32_16x16x32_bf16 v[196:199], a[52:55], a[84:87], v[196:199]
  v_mfma_f32_16x16x32_bf16 v[200:203], a[52:55], a[88:91], v[200:203]
  buffer_load_dwordx4 v25, s[80:83], s60 offen offset:3072  lds
  v_mfma_f32_16x16x32_bf16 v[204:207], a[52:55], a[92:95], v[204:207]
  v_mfma_f32_16x16x32_bf16 v[208:211], a[52:55], a[96:99], v[208:211]
  s_add_u32 m0, s52, 28672
  v_mfma_f32_16x16x32_bf16 v[212:215], a[52:55], a[100:103], v[212:215]
  v_mfma_f32_16x16x32_bf16 v[216:219], a[56:59], a[84:87], v[216:219]
  s_mov_b32 s60, 212992
  v_mfma_f32_16x16x32_bf16 v[220:223], a[56:59], a[88:91], v[220:223]
  v_mfma_f32_16x16x32_bf16 v[224:227], a[56:59], a[92:95], v[224:227]
  buffer_load_dwordx4 v4, s[80:83], s60 offen  lds
  v_mfma_f32_16x16x32_bf16 v[228:231], a[56:59], a[96:99], v[228:231]
  v_mfma_f32_16x16x32_bf16 v[232:235], a[56:59], a[100:103], v[232:235]
  buffer_load_dwordx4 v5, s[80:83], s60 offen offset:1024  lds
  v_mfma_f32_16x16x32_bf16 v[236:239], a[60:63], a[84:87], v[236:239]
  v_mfma_f32_16x16x32_bf16 v[240:243], a[60:63], a[88:91], v[240:243]
  buffer_load_dwordx4 v24, s[80:83], s60 offen offset:2048  lds
  v_mfma_f32_16x16x32_bf16 v[244:247], a[60:63], a[92:95], v[244:247]
  v_mfma_f32_16x16x32_bf16 v[248:251], a[60:63], a[96:99], v[248:251]
  buffer_load_dwordx4 v25, s[80:83], s60 offen offset:3072  lds
  v_mfma_f32_16x16x32_bf16 v[252:255], a[60:63], a[100:103], v[252:255]
  s_waitcnt lgkmcnt(0)
  v_mfma_f32_16x16x32_bf16 v[96:99], a[0:3], a[64:67], v[96:99]
  s_waitcnt vmcnt(8)
  v_mfma_f32_16x16x32_bf16 v[100:103], a[0:3], a[68:71], v[100:103]
  ds_read_b128 a[84:87], v7 offset:46080
  v_mfma_f32_16x16x32_bf16 v[104:107], a[0:3], a[72:75], v[104:107]
  ds_read_b128 a[88:91], v7 offset:47104
  v_mfma_f32_16x16x32_bf16 v[108:111], a[0:3], a[76:79], v[108:111]
  ds_read_b128 a[92:95], v7 offset:48128
  v_mfma_f32_16x16x32_bf16 v[112:115], a[0:3], a[80:83], v[112:115]
  ds_read_b128 a[96:99], v7 offset:49152
  v_mfma_f32_16x16x32_bf16 v[116:119], a[4:7], a[64:67], v[116:119]
  ds_read_b128 a[100:103], v7 offset:50176
  v_mfma_f32_16x16x32_bf16 v[120:123], a[4:7], a[68:71], v[120:123]
  ds_read_b64_tr_b16 a[32:33], v8 offset:12288
  v_mfma_f32_16x16x32_bf16 v[124:127], a[4:7], a[72:75], v[124:127]
  ds_read_b64_tr_b16 a[34:35], v8 offset:16384
  v_mfma_f32_16x16x32_bf16 v[128:131], a[4:7], a[76:79], v[128:131]
  ds_read_b64_tr_b16 a[36:37], v9 offset:12288
  v_mfma_f32_16x16x32_bf16 v[132:135], a[4:7], a[80:83], v[132:135]
  ds_read_b64_tr_b16 a[38:39], v9 offset:16384
  v_mfma_f32_16x16x32_bf16 v[136:139], a[8:11], a[64:67], v[136:139]
  ds_read_b64_tr_b16 a[40:41], v10 offset:12288
  v_mfma_f32_16x16x32_bf16 v[140:143], a[8:11], a[68:71], v[140:143]
  ds_read_b64_tr_b16 a[42:43], v10 offset:16384
  v_mfma_f32_16x16x32_bf16 v[144:147], a[8:11], a[72:75], v[144:147]
  ds_read_b64_tr_b16 a[44:45], v11 offset:12288
  v_mfma_f32_16x16x32_bf16 v[148:151], a[8:11], a[76:79], v[148:151]
  ds_read_b64_tr_b16 a[46:47], v11 offset:16384
  v_mfma_f32_16x16x32_bf16 v[152:155], a[8:11], a[80:83], v[152:155]
  ds_read_b64_tr_b16 a[48:49], v12 offset:12288
  v_mfma_f32_16x16x32_bf16 v[156:159], a[12:15], a[64:67], v[156:159]
  ds_read_b64_tr_b16 a[50:51], v12 offset:16384
  v_mfma_f32_16x16x32_bf16 v[160:163], a[12:15], a[68:71], v[160:163]
  ds_read_b64_tr_b16 a[52:53], v13 offset:12288
  s_add_u32 m0, s52, 32768
  v_mfma_f32_16x16x32_bf16 v[164:167], a[12:15], a[72:75], v[164:167]
  ds_read_b64_tr_b16 a[54:55], v13 offset:16384
  v_mfma_f32_16x16x32_bf16 v[168:171], a[12:15], a[76:79], v[168:171]
  ds_read_b64_tr_b16 a[56:57], v14 offset:12288
  s_mov_b32 s60, 229376
  v_mfma_f32_16x16x32_bf16 v[172:175], a[12:15], a[80:83], v[172:175]
  ds_read_b64_tr_b16 a[58:59], v14 offset:16384
  v_mfma_f32_16x16x32_bf16 v[176:179], a[16:19], a[64:67], v[176:179]
  ds_read_b64_tr_b16 a[60:61], v15 offset:12288
  buffer_load_dwordx4 v4, s[80:83], s60 offen  lds
  v_mfma_f32_16x16x32_bf16 v[180:183], a[16:19], a[68:71], v[180:183]
  ds_read_b64_tr_b16 a[62:63], v15 offset:16384
  v_mfma_f32_16x16x32_bf16 v[184:187], a[16:19], a[72:75], v[184:187]
  buffer_load_dwordx4 v5, s[80:83], s60 offen offset:1024  lds
  v_mfma_f32_16x16x32_bf16 v[188:191], a[16:19], a[76:79], v[188:191]
  v_mfma_f32_16x16x32_bf16 v[192:195], a[16:19], a[80:83], v[192:195]
  buffer_load_dwordx4 v24, s[80:83], s60 offen offset:2048  lds
  v_mfma_f32_16x16x32_bf16 v[196:199], a[20:23], a[64:67], v[196:199]
  v_mfma_f32_16x16x32_bf16 v[200:203], a[20:23], a[68:71], v[200:203]
  buffer_load_dwordx4 v25, s[80:83], s60 offen offset:3072  lds
  v_mfma_f32_16x16x32_bf16 v[204:207], a[20:23], a[72:75], v[204:207]
  v_mfma_f32_16x16x32_bf16 v[208:211], a[20:23], a[76:79], v[208:211]
  s_add_u32 m0, s52, 36864
  v_mfma_f32_16x16x32_bf16 v[212:215], a[20:23], a[80:83], v[212:215]
  v_mfma_f32_16x16x32_bf16 v[216:219], a[24:27], a[64:67], v[216:219]
  s_mov_b32 s60, 245760
  v_mfma_f32_16x16x32_bf16 v[220:223], a[24:27], a[68:71], v[220:223]
  v_mfma_f32_16x16x32_bf16 v[224:227], a[24:27], a[72:75], v[224:227]
  buffer_load_dwordx4 v4, s[80:83], s60 offen  lds
  v_mfma_f32_16x16x32_bf16 v[228:231], a[24:27], a[76:79], v[228:231]
  v_mfma_f32_16x16x32_bf16 v[232:235], a[24:27], a[80:83], v[232:235]
  buffer_load_dwordx4 v5, s[80:83], s60 offen offset:1024  lds
  v_mfma_f32_16x16x32_bf16 v[236:239], a[28:31], a[64:67], v[236:239]
  v_mfma_f32_16x16x32_bf16 v[240:243], a[28:31], a[68:71], v[240:243]
  buffer_load_dwordx4 v24, s[80:83], s60 offen offset:2048  lds
  v_mfma_f32_16x16x32_bf16 v[244:247], a[28:31], a[72:75], v[244:247]
  v_mfma_f32_16x16x32_bf16 v[248:251], a[28:31], a[76:79], v[248:251]
  buffer_load_dwordx4 v25, s[80:83], s60 offen offset:3072  lds
  v_mfma_f32_16x16x32_bf16 v[252:255], a[28:31], a[80:83], v[252:255]
  s_waitcnt lgkmcnt(0)
  v_mfma_f32_16x16x32_bf16 v[96:99], a[32:35], a[84:87], v[96:99]
  s_waitcnt vmcnt(8)
  v_mfma_f32_16x16x32_bf16 v[100:103], a[32:35], a[88:91], v[100:103]
  ds_read_b128 a[64:67], v7 offset:0
  ds_read_b128 a[68:71], v7 offset:1024
  v_mfma_f32_16x16x32_bf16 v[104:107], a[32:35], a[92:95], v[104:107]
  ds_read_b128 a[72:75], v7 offset:2048
  v_mfma_f32_16x16x32_bf16 v[108:111], a[32:35], a[96:99], v[108:111]
  ds_read_b128 a[76:79], v7 offset:3072
  v_mfma_f32_16x16x32_bf16 v[112:115], a[32:35], a[100:103], v[112:115]
  ds_read_b128 a[80:83], v7 offset:4096
  v_mfma_f32_16x16x32_bf16 v[116:119], a[36:39], a[84:87], v[116:119]
  ds_read_b64_tr_b16 a[0:1], v8 offset:24576
  ds_read_b64_tr_b16 a[2:3], v8 offset:28672
  v_mfma_f32_16x16x32_bf16 v[120:123], a[36:39], a[88:91], v[120:123]
  ds_read_b64_tr_b16 a[4:5], v9 offset:24576
  v_mfma_f32_16x16x32_bf16 v[124:127], a[36:39], a[92:95], v[124:127]
  ds_read_b64_tr_b16 a[6:7], v9 offset:28672
  v_mfma_f32_16x16x32_bf16 v[128:131], a[36:39], a[96:99], v[128:131]
  ds_read_b64_tr_b16 a[8:9], v10 offset:24576
  v_mfma_f32_16x16x32_bf16 v[132:135], a[36:39], a[100:103], v[132:135]
  ds_read_b64_tr_b16 a[10:11], v10 offset:28672
  ds_read_b64_tr_b16 a[12:13], v11 offset:24576
  v_mfma_f32_16x16x32_bf16 v[136:139], a[40:43], a[84:87], v[136:139]
  ds_read_b64_tr_b16 a[14:15], v11 offset:28672
  v_mfma_f32_16x16x32_bf16 v[140:143], a[40:43], a[88:91], v[140:143]
  ds_read_b64_tr_b16 a[16:17], v12 offset:24576
  v_mfma_f32_16x16x32_bf16 v[144:147], a[40:43], a[92:95], v[144:147]
  ds_read_b64_tr_b16 a[18:19], v12 offset:28672
  v_mfma_f32_16x16x32_bf16 v[148:151], a[40:43], a[96:99], v[148:151]
  ds_read_b64_tr_b16 a[20:21], v13 offset:24576
  ds_read_b64_tr_b16 a[22:23], v13 offset:28672
  v_mfma_f32_16x16x32_bf16 v[152:155], a[40:43], a[100:103], v[152:155]
  ds_read_b64_tr_b16 a[24:25], v14 offset:24576
  v_mfma_f32_16x16x32_bf16 v[156:159], a[44:47], a[84:87], v[156:159]
  ds_read_b64_tr_b16 a[26:27], v14 offset:28672
  v_mfma_f32_16x16x32_bf16 v[160:163], a[44:47], a[88:91], v[160:163]
  ds_read_b64_tr_b16 a[28:29], v15 offset:24576
  v_mfma_f32_16x16x32_bf16 v[164:167], a[44:47], a[92:95], v[164:167]
  ds_read_b64_tr_b16 a[30:31], v15 offset:28672
  v_mfma_f32_16x16x32_bf16 v[168:171], a[44:47], a[96:99], v[168:171]
  s_waitcnt vmcnt(0)
  v_mfma_f32_16x16x32_bf16 v[172:175], a[44:47], a[100:103], v[172:175]
  ds_read_b128 a[136:139], v7 offset:5120
  ds_read_b128 a[140:143], v7 offset:6144
  v_mfma_f32_16x16x32_bf16 v[176:179], a[48:51], a[84:87], v[176:179]
  ds_read_b128 a[144:147], v7 offset:7168
  v_mfma_f32_16x16x32_bf16 v[180:183], a[48:51], a[88:91], v[180:183]
  ds_read_b128 a[148:151], v7 offset:8192
  v_mfma_f32_16x16x32_bf16 v[184:187], a[48:51], a[92:95], v[184:187]
  ds_read_b128 a[152:155], v7 offset:9216
  v_mfma_f32_16x16x32_bf16 v[188:191], a[48:51], a[96:99], v[188:191]
  ds_read_b64_tr_b16 a[104:105], v8 offset:32768
  v_mfma_f32_16x16x32_bf16 v[192:195], a[48:51], a[100:103], v[192:195]
  ds_read_b64_tr_b16 a[106:107], v8 offset:36864
  v_mfma_f32_16x16x32_bf16 v[196:199], a[52:55], a[84:87], v[196:199]
  ds_read_b64_tr_b16 a[108:109], v9 offset:32768
  v_mfma_f32_16x16x32_bf16 v[200:203], a[52:55], a[88:91], v[200:203]
  ds_read_b64_tr_b16 a[110:111], v9 offset:36864
  v_mfma_f32_16x16x32_bf16 v[204:207], a[52:55], a[92:95], v[204:207]
  ds_read_b64_tr_b16 a[112:113], v10 offset:32768
  v_mfma_f32_16x16x32_bf16 v[208:211], a[52:55], a[96:99], v[208:211]
  ds_read_b64_tr_b16 a[114:115], v10 offset:36864
  ds_read_b64_tr_b16 a[116:117], v11 offset:32768
  v_mfma_f32_16x16x32_bf16 v[212:215], a[52:55], a[100:103], v[212:215]
  ds_read_b64_tr_b16 a[118:119], v11 offset:36864
  v_mfma_f32_16x16x32_bf16 v[216:219], a[56:59], a[84:87], v[216:219]
  ds_read_b64_tr_b16 a[120:121], v12 offset:32768
  v_mfma_f32_16x16x32_bf16 v[220:223], a[56:59], a[88:91], v[220:223]
  ds_read_b64_tr_b16 a[122:123], v12 offset:36864
  v_mfma_f32_16x16x32_bf16 v[224:227], a[56:59], a[92:95], v[224:227]
  ds_read_b64_tr_b16 a[124:125], v13 offset:32768
  v_mfma_f32_16x16x32_bf16 v[228:231], a[56:59], a[96:99], v[228:231]
  ds_read_b64_tr_b16 a[126:127], v13 offset:36864
  v_mfma_f32_16x16x32_bf16 v[232:235], a[56:59], a[100:103], v[232:235]
  ds_read_b64_tr_b16 a[128:129], v14 offset:32768
  v_mfma_f32_16x16x32_bf16 v[236:239], a[60:63], a[84:87], v[236:239]
  ds_read_b64_tr_b16 a[130:131], v14 offset:36864
  v_mfma_f32_16x16x32_bf16 v[240:243], a[60:63], a[88:91], v[240:243]
  ds_read_b64_tr_b16 a[132:133], v15 offset:32768
  v_mfma_f32_16x16x32_bf16 v[244:247], a[60:63], a[92:95], v[244:247]
  ds_read_b64_tr_b16 a[134:135], v15 offset:36864
  v_mfma_f32_16x16x32_bf16 v[248:251], a[60:63], a[96:99], v[248:251]
  v_mfma_f32_16x16x32_bf16 v[252:255], a[60:63], a[100:103], v[252:255]
  s_waitcnt lgkmcnt(0)
  v_mfma_f32_16x16x32_bf16 v[96:99], a[0:3], a[64:67], v[96:99]
  v_mfma_f32_16x16x32_bf16 v[100:103], a[0:3], a[68:71], v[100:103]
  v_mfma_f32_16x16x32_bf16 v[104:107], a[0:3], a[72:75], v[104:107]
  v_mfma_f32_16x16x32_bf16 v[108:111], a[0:3], a[76:79], v[108:111]
  v_mfma_f32_16x16x32_bf16 v[112:115], a[0:3], a[80:83], v[112:115]
  v_mfma_f32_16x16x32_bf16 v[96:99], a[104:107], a[136:139], v[96:99]
  v_mfma_f32_16x16x32_bf16 v[100:103], a[104:107], a[140:143], v[100:103]
  v_mfma_f32_16x16x32_bf16 v[104:107], a[104:107], a[144:147], v[104:107]
  v_mfma_f32_16x16x32_bf16 v[108:111], a[104:107], a[148:151], v[108:111]
  v_mfma_f32_16x16x32_bf16 v[112:115], a[104:107], a[152:155], v[112:115]
  v_mfma_f32_16x16x32_bf16 v[116:119], a[4:7], a[64:67], v[116:119]
  v_mfma_f32_16x16x32_bf16 v[120:123], a[4:7], a[68:71], v[120:123]
  v_mfma_f32_16x16x32_bf16 v[124:127], a[4:7], a[72:75], v[124:127]
  v_mfma_f32_16x16x32_bf16 v[128:131], a[4:7], a[76:79], v[128:131]
  v_mfma_f32_16x16x32_bf16 v[132:135], a[4:7], a[80:83], v[132:135]
  v_mfma_f32_16x16x32_bf16 v[116:119], a[108:111], a[136:139], v[116:119]
  v_mfma_f32_16x16x32_bf16 v[120:123], a[108:111], a[140:143], v[120:123]
  v_mfma_f32_16x16x32_bf16 v[124:127], a[108:111], a[144:147], v[124:127]
  v_mfma_f32_16x16x32_bf16 v[128:131], a[108:111], a[148:151], v[128:131]
  v_mfma_f32_16x16x32_bf16 v[132:135], a[108:111], a[152:155], v[132:135]
  v_mfma_f32_16x16x32_bf16 v[136:139], a[8:11], a[64:67], v[136:139]
  v_mfma_f32_16x16x32_bf16 v[140:143], a[8:11], a[68:71], v[140:143]
  v_mfma_f32_16x16x32_bf16 v[144:147], a[8:11], a[72:75], v[144:147]
  v_mfma_f32_16x16x32_bf16 v[148:151], a[8:11], a[76:79], v[148:151]
  v_mfma_f32_16x16x32_bf16 v[152:155], a[8:11], a[80:83], v[152:155]
  s_lshl_b32 s59, s27, 1
  s_xor_b32 s59, s59, 0
  s_mul_i32 s59, s59, 5120
  v_mfma_f32_16x16x32_bf16 v[136:139], a[112:115], a[136:139], v[136:139]
  v_cvt_pk_bf16_f32 v32, v96, v97
  v_cvt_pk_bf16_f32 v33, v98, v99
  v_mfma_f32_16x16x32_bf16 v[140:143], a[112:115], a[140:143], v[140:143]
  v_cvt_pk_bf16_f32 v34, v116, v117
  v_cvt_pk_bf16_f32 v35, v118, v119
  v_mfma_f32_16x16x32_bf16 v[144:147], a[112:115], a[144:147], v[144:147]
  buffer_store_dwordx4 v[32:35], v2, s[48:51], s59 offen sc1
  s_add_u32 s59, s59, 1024
  v_mfma_f32_16x16x32_bf16 v[148:151], a[112:115], a[148:151], v[148:151]
  v_cvt_pk_bf16_f32 v36, v100, v101
  v_cvt_pk_bf16_f32 v37, v102, v103
  v_mfma_f32_16x16x32_bf16 v[152:155], a[112:115], a[152:155], v[152:155]
  v_cvt_pk_bf16_f32 v38, v120, v121
  v_cvt_pk_bf16_f32 v39, v122, v123
  v_mfma_f32_16x16x32_bf16 v[156:159], a[12:15], a[64:67], v[156:159]
  buffer_store_dwordx4 v[36:39], v2, s[48:51], s59 offen sc1
  s_add_u32 s59, s59, 1024
  v_mfma_f32_16x16x32_bf16 v[160:163], a[12:15], a[68:71], v[160:163]
  v_cvt_pk_bf16_f32 v40, v104, v105
  v_cvt_pk_bf16_f32 v41, v106, v107
  v_mfma_f32_16x16x32_bf16 v[164:167], a[12:15], a[72:75], v[164:167]
  v_cvt_pk_bf16_f32 v42, v124, v125
  v_cvt_pk_bf16_f32 v43, v126, v127
  v_mfma_f32_16x16x32_bf16 v[168:171], a[12:15], a[76:79], v[168:171]
  buffer_store_dwordx4 v[40:43], v2, s[48:51], s59 offen sc1
  s_add_u32 s59, s59, 1024
  v_mfma_f32_16x16x32_bf16 v[172:175], a[12:15], a[80:83], v[172:175]
  v_cvt_pk_bf16_f32 v44, v108, v109
  v_cvt_pk_bf16_f32 v45, v110, v111
  v_mfma_f32_16x16x32_bf16 v[156:159], a[116:119], a[136:139], v[156:159]
  v_cvt_pk_bf16_f32 v46, v128, v129
  v_cvt_pk_bf16_f32 v47, v130, v131
  v_mfma_f32_16x16x32_bf16 v[160:163], a[116:119], a[140:143], v[160:163]
  buffer_store_dwordx4 v[44:47], v2, s[48:51], s59 offen sc1
  s_add_u32 s59, s59, 1024
  v_mfma_f32_16x16x32_bf16 v[164:167], a[116:119], a[144:147], v[164:167]
  v_cvt_pk_bf16_f32 v32, v112, v113
  v_cvt_pk_bf16_f32 v33, v114, v115
  v_mfma_f32_16x16x32_bf16 v[168:171], a[116:119], a[148:151], v[168:171]
  v_cvt_pk_bf16_f32 v34, v132, v133
  v_cvt_pk_bf16_f32 v35, v134, v135
  v_mfma_f32_16x16x32_bf16 v[172:175], a[116:119], a[152:155], v[172:175]
  buffer_store_dwordx4 v[32:35], v2, s[48:51], s59 offen sc1
  s_add_u32 s59, s59, 1024
  v_mfma_f32_16x16x32_bf16 v[176:179], a[16:19], a[64:67], v[176:179]
  v_mfma_f32_16x16x32_bf16 v[180:183], a[16:19], a[68:71], v[180:183]
  v_mfma_f32_16x16x32_bf16 v[184:187], a[16:19], a[72:75], v[184:187]
  v_mfma_f32_16x16x32_bf16 v[188:191], a[16:19], a[76:79], v[188:191]
  v_mfma_f32_16x16x32_bf16 v[192:195], a[16:19], a[80:83], v[192:195]
  s_lshl_b32 s59, s27, 1
  s_xor_b32 s59, s59, 1
  s_mul_i32 s59, s59, 5120
  v_mfma_f32_16x16x32_bf16 v[176:179], a[120:123], a[136:139], v[176:179]
  v_cvt_pk_bf16_f32 v36, v136, v137
  v_cvt_pk_bf16_f32 v37, v138, v139
  v_mfma_f32_16x16x32_bf16 v[180:183], a[120:123], a[140:143], v[180:183]
  v_cvt_pk_bf16_f32 v38, v156, v157
  v_cvt_pk_bf16_f32 v39, v158, v159
  v_mfma_f32_16x16x32_bf16 v[184:187], a[120:123], a[144:147], v[184:187]
  buffer_store_dwordx4 v[36:39], v2, s[48:51], s59 offen sc1
  s_add_u32 s59, s59, 1024
  v_mfma_f32_16x16x32_bf16 v[188:191], a[120:123], a[148:151], v[188:191]
  v_cvt_pk_bf16_f32 v40, v140, v141
  v_cvt_pk_bf16_f32 v41, v142, v143
  v_mfma_f32_16x16x32_bf16 v[192:195], a[120:123], a[152:155], v[192:195]
  v_cvt_pk_bf16_f32 v42, v160, v161
  v_cvt_pk_bf16_f32 v43, v162, v163
  v_mfma_f32_16x16x32_bf16 v[196:199], a[20:23], a[64:67], v[196:199]
  buffer_store_dwordx4 v[40:43], v2, s[48:51], s59 offen sc1
  s_add_u32 s59, s59, 1024
  v_mfma_f32_16x16x32_bf16 v[200:203], a[20:23], a[68:71], v[200:203]
  v_cvt_pk_bf16_f32 v44, v144, v145
  v_cvt_pk_bf16_f32 v45, v146, v147
  v_mfma_f32_16x16x32_bf16 v[204:207], a[20:23], a[72:75], v[204:207]
  v_cvt_pk_bf16_f32 v46, v164, v165
  v_cvt_pk_bf16_f32 v47, v166, v167
  v_mfma_f32_16x16x32_bf16 v[208:211], a[20:23], a[76:79], v[208:211]
  buffer_store_dwordx4 v[44:47], v2, s[48:51], s59 offen sc1
  s_add_u32 s59, s59, 1024
  v_mfma_f32_16x16x32_bf16 v[212:215], a[20:23], a[80:83], v[212:215]
  v_cvt_pk_bf16_f32 v32, v148, v149
  v_cvt_pk_bf16_f32 v33, v150, v151
  v_mfma_f32_16x16x32_bf16 v[196:199], a[124:127], a[136:139], v[196:199]
  v_cvt_pk_bf16_f32 v34, v168, v169
  v_cvt_pk_bf16_f32 v35, v170, v171
  v_mfma_f32_16x16x32_bf16 v[200:203], a[124:127], a[140:143], v[200:203]
  buffer_store_dwordx4 v[32:35], v2, s[48:51], s59 offen sc1
  s_add_u32 s59, s59, 1024
  v_mfma_f32_16x16x32_bf16 v[204:207], a[124:127], a[144:147], v[204:207]
  v_cvt_pk_bf16_f32 v36, v152, v153
  v_cvt_pk_bf16_f32 v37, v154, v155
  v_mfma_f32_16x16x32_bf16 v[208:211], a[124:127], a[148:151], v[208:211]
  v_cvt_pk_bf16_f32 v38, v172, v173
  v_cvt_pk_bf16_f32 v39, v174, v175
  v_mfma_f32_16x16x32_bf16 v[212:215], a[124:127], a[152:155], v[212:215]
  buffer_store_dwordx4 v[36:39], v2, s[48:51], s59 offen sc1
  s_add_u32 s59, s59, 1024
  v_mfma_f32_16x16x32_bf16 v[216:219], a[24:27], a[64:67], v[216:219]
  v_mfma_f32_16x16x32_bf16 v[220:223], a[24:27], a[68:71], v[220:223]
  v_mfma_f32_16x16x32_bf16 v[224:227], a[24:27], a[72:75], v[224:227]
  v_mfma_f32_16x16x32_bf16 v[228:231], a[24:27], a[76:79], v[228:231]
  v_mfma_f32_16x16x32_bf16 v[232:235], a[24:27], a[80:83], v[232:235]
  s_lshl_b32 s59, s27, 1
  s_xor_b32 s59, s59, 2
  s_mul_i32 s59, s59, 5120
  v_mfma_f32_16x16x32_bf16 v[216:219], a[128:131], a[136:139], v[216:219]
  v_cvt_pk_bf16_f32 v40, v176, v177
  v_cvt_pk_bf16_f32 v41, v178, v179
  v_mfma_f32_16x16x32_bf16 v[220:223], a[128:131], a[140:143], v[220:223]
  v_cvt_pk_bf16_f32 v42, v196, v197
  v_cvt_pk_bf16_f32 v43, v198, v199
  v_mfma_f32_16x16x32_bf16 v[224:227], a[128:131], a[144:147], v[224:227]
  buffer_store_dwordx4 v[40:43], v2, s[48:51], s59 offen sc1
  s_add_u32 s59, s59, 1024
  v_mfma_f32_16x16x32_bf16 v[228:231], a[128:131], a[148:151], v[228:231]
  v_cvt_pk_bf16_f32 v44, v180, v181
  v_cvt_pk_bf16_f32 v45, v182, v183
  v_mfma_f32_16x16x32_bf16 v[232:235], a[128:131], a[152:155], v[232:235]
  v_cvt_pk_bf16_f32 v46, v200, v201
  v_cvt_pk_bf16_f32 v47, v202, v203
  v_mfma_f32_16x16x32_bf16 v[236:239], a[28:31], a[64:67], v[236:239]
  buffer_store_dwordx4 v[44:47], v2, s[48:51], s59 offen sc1
  s_add_u32 s59, s59, 1024
  v_mfma_f32_16x16x32_bf16 v[240:243], a[28:31], a[68:71], v[240:243]
  v_cvt_pk_bf16_f32 v32, v184, v185
  v_cvt_pk_bf16_f32 v33, v186, v187
  v_mfma_f32_16x16x32_bf16 v[244:247], a[28:31], a[72:75], v[244:247]
  v_cvt_pk_bf16_f32 v34, v204, v205
  v_cvt_pk_bf16_f32 v35, v206, v207
  v_mfma_f32_16x16x32_bf16 v[248:251], a[28:31], a[76:79], v[248:251]
  buffer_store_dwordx4 v[32:35], v2, s[48:51], s59 offen sc1
  s_add_u32 s59, s59, 1024
  v_mfma_f32_16x16x32_bf16 v[252:255], a[28:31], a[80:83], v[252:255]
  v_cvt_pk_bf16_f32 v36, v188, v189
  v_cvt_pk_bf16_f32 v37, v190, v191
  v_mfma_f32_16x16x32_bf16 v[236:239], a[132:135], a[136:139], v[236:239]
  v_cvt_pk_bf16_f32 v38, v208, v209
  v_cvt_pk_bf16_f32 v39, v210, v211
  v_mfma_f32_16x16x32_bf16 v[240:243], a[132:135], a[140:143], v[240:243]
  buffer_store_dwordx4 v[36:39], v2, s[48:51], s59 offen sc1
  s_add_u32 s59, s59, 1024
  v_mfma_f32_16x16x32_bf16 v[244:247], a[132:135], a[144:147], v[244:247]
  v_cvt_pk_bf16_f32 v40, v192, v193
  v_cvt_pk_bf16_f32 v41, v194, v195
  v_mfma_f32_16x16x32_bf16 v[248:251], a[132:135], a[148:151], v[248:251]
  v_cvt_pk_bf16_f32 v42, v212, v213
  v_cvt_pk_bf16_f32 v43, v214, v215
  v_mfma_f32_16x16x32_bf16 v[252:255], a[132:135], a[152:155], v[252:255]
  buffer_store_dwordx4 v[40:43], v2, s[48:51], s59 offen sc1
  s_add_u32 s59, s59, 1024
  s_nop 7
  s_lshl_b32 s59, s27, 1
  s_xor_b32 s59, s59, 3
  s_mul_i32 s59, s59, 5120
  v_cvt_pk_bf16_f32 v44, v216, v217
  v_cvt_pk_bf16_f32 v45, v218, v219
  v_cvt_pk_bf16_f32 v46, v236, v237
  v_cvt_pk_bf16_f32 v47, v238, v239
  buffer_store_dwordx4 v[44:47], v2, s[48:51], s59 offen sc1
  s_add_u32 s59, s59, 1024
  v_cvt_pk_bf16_f32 v32, v220, v221
  v_cvt_pk_bf16_f32 v33, v222, v223
  v_cvt_pk_bf16_f32 v34, v240, v241
  v_cvt_pk_bf16_f32 v35, v242, v243
  buffer_store_dwordx4 v[32:35], v2, s[48:51], s59 offen sc1
  s_add_u32 s59, s59, 1024
  v_cvt_pk_bf16_f32 v36, v224, v225
  v_cvt_pk_bf16_f32 v37, v226, v227
  v_cvt_pk_bf16_f32 v38, v244, v245
  v_cvt_pk_bf16_f32 v39, v246, v247
  buffer_store_dwordx4 v[36:39], v2, s[48:51], s59 offen sc1
  s_add_u32 s59, s59, 1024
  v_cvt_pk_bf16_f32 v40, v228, v229
  v_cvt_pk_bf16_f32 v41, v230, v231
  v_cvt_pk_bf16_f32 v42, v248, v249
  v_cvt_pk_bf16_f32 v43, v250, v251
  buffer_store_dwordx4 v[40:43], v2, s[48:51], s59 offen sc1
  s_add_u32 s59, s59, 1024
  v_cvt_pk_bf16_f32 v44, v232, v233
  v_cvt_pk_bf16_f32 v45, v234, v235
  v_cvt_pk_bf16_f32 v46, v252, v253
  v_cvt_pk_bf16_f32 v47, v254, v255
  buffer_store_dwordx4 v[44:47], v2, s[48:51], s59 offen sc1
  s_add_u32 s59, s59, 1024
  s_load_dwordx2 s[6:7], s[0:1], 88
  s_load_dwordx2 s[12:13], s[0:1], 80
  s_lshl_b32 s59, s28, 3
  s_add_u32 s59, s59, s29
  s_lshl_b32 s73, s59, 4
  s_waitcnt vmcnt(0) lgkmcnt(0)
  s_barrier
  s_cmp_lg_u32 s26, 0
  s_cbranch_scc1 concat_heads__gqa_block_cached__mha_block_cached__near_ridge_kernel_wait
  v_mov_b32 v30, s73
  v_mov_b32 v31, 1
  s_mov_b64 s[22:23], exec
  s_mov_b64 exec, 1
  global_atomic_add v30, v31, s[6:7] sc1
  s_mov_b32 s63, 0x20000
  v_mov_b32 v29, 0
concat_heads__gqa_block_cached__mha_block_cached__near_ridge_kernel_poll:
  global_atomic_add v31, v30, v29, s[6:7] sc0 sc1
  s_sub_u32 s63, s63, 1
  s_waitcnt vmcnt(0)
  v_readfirstlane_b32 s60, v31
  s_cmp_eq_u32 s63, 0
  s_cbranch_scc1 concat_heads__gqa_block_cached__mha_block_cached__near_ridge_kernel_polled
  s_cmp_ge_u32 s60, 16
  s_cbranch_scc1 concat_heads__gqa_block_cached__mha_block_cached__near_ridge_kernel_polled
  s_sleep 16
  s_branch concat_heads__gqa_block_cached__mha_block_cached__near_ridge_kernel_poll
concat_heads__gqa_block_cached__mha_block_cached__near_ridge_kernel_polled:
  s_mov_b64 exec, s[22:23]
concat_heads__gqa_block_cached__mha_block_cached__near_ridge_kernel_wait:
  s_barrier
  s_lshl_b32 s60, s59, 4
  s_lshl_b32 s61, s26, 2
  s_add_u32 s60, s60, s61
  s_mul_i32 s60, s60, 81920
  s_lshr_b32 s62, s30, 1
  s_mul_i32 s61, s62, 5120
  s_add_u32 s60, s60, s61
  s_add_u32 s76, s24, s60
  s_addc_u32 s77, s25, 0
  s_mov_b32 s78, 250880
  s_mov_b32 s79, 0x20000
  s_mov_b32 s60, 0
  buffer_load_dwordx4 v[16:19], v2, s[76:79], s60 offen sc1
  s_mov_b32 s60, 1024
  buffer_load_dwordx4 v[20:23], v2, s[76:79], s60 offen sc1
  s_mov_b32 s60, 2048
  buffer_load_dwordx4 v[24:27], v2, s[76:79], s60 offen sc1
  s_mov_b32 s60, 3072
  buffer_load_dwordx4 v[28:31], v2, s[76:79], s60 offen sc1
  s_mov_b32 s60, 4096
  buffer_load_dwordx4 v[32:35], v2, s[76:79], s60 offen sc1
  s_mov_b32 s60, 81920
  buffer_load_dwordx4 v[36:39], v2, s[76:79], s60 offen sc1
  s_mov_b32 s60, 82944
  buffer_load_dwordx4 v[40:43], v2, s[76:79], s60 offen sc1
  s_mov_b32 s60, 83968
  buffer_load_dwordx4 v[44:47], v2, s[76:79], s60 offen sc1
  s_mov_b32 s60, 84992
  buffer_load_dwordx4 v[48:51], v2, s[76:79], s60 offen sc1
  s_mov_b32 s60, 86016
  buffer_load_dwordx4 v[52:55], v2, s[76:79], s60 offen sc1
  s_mov_b32 s60, 163840
  buffer_load_dwordx4 v[56:59], v2, s[76:79], s60 offen sc1
  s_mov_b32 s60, 164864
  buffer_load_dwordx4 v[60:63], v2, s[76:79], s60 offen sc1
  s_mov_b32 s60, 165888
  buffer_load_dwordx4 v[64:67], v2, s[76:79], s60 offen sc1
  s_mov_b32 s60, 166912
  buffer_load_dwordx4 v[68:71], v2, s[76:79], s60 offen sc1
  s_mov_b32 s60, 167936
  buffer_load_dwordx4 v[72:75], v2, s[76:79], s60 offen sc1
  s_mov_b32 s60, 245760
  buffer_load_dwordx4 v[76:79], v2, s[76:79], s60 offen sc1
  s_mov_b32 s60, 246784
  buffer_load_dwordx4 v[80:83], v2, s[76:79], s60 offen sc1
  s_mov_b32 s60, 247808
  buffer_load_dwordx4 v[84:87], v2, s[76:79], s60 offen sc1
  s_mov_b32 s60, 248832
  buffer_load_dwordx4 v[88:91], v2, s[76:79], s60 offen sc1
  s_mov_b32 s60, 249856
  buffer_load_dwordx4 v[92:95], v2, s[76:79], s60 offen sc1
  s_mul_i32 s60, s29, 163840
  s_lshl_b32 s61, s28, 10
  s_add_u32 s60, s60, s61
  s_lshl_b32 s61, s62, 6
  s_add_u32 s60, s60, s61
  s_add_u32 s48, s12, s60
  s_addc_u32 s49, s13, 0
  s_sub_u32 s50, 1310720, s60
  s_mov_b32 s51, 0x20000
  s_waitcnt vmcnt(15)
  v_lshlrev_b32 v100, 16, v16
  v_and_b32 v101, 0xffff0000, v16
  v_lshlrev_b32 v102, 16, v17
  v_and_b32 v103, 0xffff0000, v17
  v_lshlrev_b32 v104, 16, v18
  v_and_b32 v105, 0xffff0000, v18
  v_lshlrev_b32 v106, 16, v19
  v_and_b32 v107, 0xffff0000, v19
  v_lshlrev_b32 v108, 16, v20
  v_and_b32 v109, 0xffff0000, v20
  v_lshlrev_b32 v110, 16, v21
  v_and_b32 v111, 0xffff0000, v21
  v_lshlrev_b32 v112, 16, v22
  v_and_b32 v113, 0xffff0000, v22
  v_lshlrev_b32 v114, 16, v23
  v_and_b32 v115, 0xffff0000, v23
  v_lshlrev_b32 v116, 16, v24
  v_and_b32 v117, 0xffff0000, v24
  v_lshlrev_b32 v118, 16, v25
  v_and_b32 v119, 0xffff0000, v25
  v_lshlrev_b32 v120, 16, v26
  v_and_b32 v121, 0xffff0000, v26
  v_lshlrev_b32 v122, 16, v27
  v_and_b32 v123, 0xffff0000, v27
  v_lshlrev_b32 v124, 16, v28
  v_and_b32 v125, 0xffff0000, v28
  v_lshlrev_b32 v126, 16, v29
  v_and_b32 v127, 0xffff0000, v29
  v_lshlrev_b32 v128, 16, v30
  v_and_b32 v129, 0xffff0000, v30
  v_lshlrev_b32 v130, 16, v31
  v_and_b32 v131, 0xffff0000, v31
  v_lshlrev_b32 v132, 16, v32
  v_and_b32 v133, 0xffff0000, v32
  v_lshlrev_b32 v134, 16, v33
  v_and_b32 v135, 0xffff0000, v33
  v_lshlrev_b32 v136, 16, v34
  v_and_b32 v137, 0xffff0000, v34
  v_lshlrev_b32 v138, 16, v35
  v_and_b32 v139, 0xffff0000, v35
  s_waitcnt vmcnt(10)
  v_lshlrev_b32 v4, 16, v36
  v_and_b32 v5, 0xffff0000, v36
  v_pk_add_f32 v[100:101], v[100:101], v[4:5]
  v_lshlrev_b32 v4, 16, v37
  v_and_b32 v5, 0xffff0000, v37
  v_pk_add_f32 v[102:103], v[102:103], v[4:5]
  v_lshlrev_b32 v4, 16, v38
  v_and_b32 v5, 0xffff0000, v38
  v_pk_add_f32 v[104:105], v[104:105], v[4:5]
  v_lshlrev_b32 v4, 16, v39
  v_and_b32 v5, 0xffff0000, v39
  v_pk_add_f32 v[106:107], v[106:107], v[4:5]
  v_lshlrev_b32 v4, 16, v40
  v_and_b32 v5, 0xffff0000, v40
  v_pk_add_f32 v[108:109], v[108:109], v[4:5]
  v_lshlrev_b32 v4, 16, v41
  v_and_b32 v5, 0xffff0000, v41
  v_pk_add_f32 v[110:111], v[110:111], v[4:5]
  v_lshlrev_b32 v4, 16, v42
  v_and_b32 v5, 0xffff0000, v42
  v_pk_add_f32 v[112:113], v[112:113], v[4:5]
  v_lshlrev_b32 v4, 16, v43
  v_and_b32 v5, 0xffff0000, v43
  v_pk_add_f32 v[114:115], v[114:115], v[4:5]
  v_lshlrev_b32 v4, 16, v44
  v_and_b32 v5, 0xffff0000, v44
  v_pk_add_f32 v[116:117], v[116:117], v[4:5]
  v_lshlrev_b32 v4, 16, v45
  v_and_b32 v5, 0xffff0000, v45
  v_pk_add_f32 v[118:119], v[118:119], v[4:5]
  v_lshlrev_b32 v4, 16, v46
  v_and_b32 v5, 0xffff0000, v46
  v_pk_add_f32 v[120:121], v[120:121], v[4:5]
  v_lshlrev_b32 v4, 16, v47
  v_and_b32 v5, 0xffff0000, v47
  v_pk_add_f32 v[122:123], v[122:123], v[4:5]
  v_lshlrev_b32 v4, 16, v48
  v_and_b32 v5, 0xffff0000, v48
  v_pk_add_f32 v[124:125], v[124:125], v[4:5]
  v_lshlrev_b32 v4, 16, v49
  v_and_b32 v5, 0xffff0000, v49
  v_pk_add_f32 v[126:127], v[126:127], v[4:5]
  v_lshlrev_b32 v4, 16, v50
  v_and_b32 v5, 0xffff0000, v50
  v_pk_add_f32 v[128:129], v[128:129], v[4:5]
  v_lshlrev_b32 v4, 16, v51
  v_and_b32 v5, 0xffff0000, v51
  v_pk_add_f32 v[130:131], v[130:131], v[4:5]
  v_lshlrev_b32 v4, 16, v52
  v_and_b32 v5, 0xffff0000, v52
  v_pk_add_f32 v[132:133], v[132:133], v[4:5]
  v_lshlrev_b32 v4, 16, v53
  v_and_b32 v5, 0xffff0000, v53
  v_pk_add_f32 v[134:135], v[134:135], v[4:5]
  v_lshlrev_b32 v4, 16, v54
  v_and_b32 v5, 0xffff0000, v54
  v_pk_add_f32 v[136:137], v[136:137], v[4:5]
  v_lshlrev_b32 v4, 16, v55
  v_and_b32 v5, 0xffff0000, v55
  v_pk_add_f32 v[138:139], v[138:139], v[4:5]
  s_waitcnt vmcnt(5)
  v_lshlrev_b32 v4, 16, v56
  v_and_b32 v5, 0xffff0000, v56
  v_pk_add_f32 v[100:101], v[100:101], v[4:5]
  v_lshlrev_b32 v4, 16, v57
  v_and_b32 v5, 0xffff0000, v57
  v_pk_add_f32 v[102:103], v[102:103], v[4:5]
  v_lshlrev_b32 v4, 16, v58
  v_and_b32 v5, 0xffff0000, v58
  v_pk_add_f32 v[104:105], v[104:105], v[4:5]
  v_lshlrev_b32 v4, 16, v59
  v_and_b32 v5, 0xffff0000, v59
  v_pk_add_f32 v[106:107], v[106:107], v[4:5]
  v_lshlrev_b32 v4, 16, v60
  v_and_b32 v5, 0xffff0000, v60
  v_pk_add_f32 v[108:109], v[108:109], v[4:5]
  v_lshlrev_b32 v4, 16, v61
  v_and_b32 v5, 0xffff0000, v61
  v_pk_add_f32 v[110:111], v[110:111], v[4:5]
  v_lshlrev_b32 v4, 16, v62
  v_and_b32 v5, 0xffff0000, v62
  v_pk_add_f32 v[112:113], v[112:113], v[4:5]
  v_lshlrev_b32 v4, 16, v63
  v_and_b32 v5, 0xffff0000, v63
  v_pk_add_f32 v[114:115], v[114:115], v[4:5]
  v_lshlrev_b32 v4, 16, v64
  v_and_b32 v5, 0xffff0000, v64
  v_pk_add_f32 v[116:117], v[116:117], v[4:5]
  v_lshlrev_b32 v4, 16, v65
  v_and_b32 v5, 0xffff0000, v65
  v_pk_add_f32 v[118:119], v[118:119], v[4:5]
  v_lshlrev_b32 v4, 16, v66
  v_and_b32 v5, 0xffff0000, v66
  v_pk_add_f32 v[120:121], v[120:121], v[4:5]
  v_lshlrev_b32 v4, 16, v67
  v_and_b32 v5, 0xffff0000, v67
  v_pk_add_f32 v[122:123], v[122:123], v[4:5]
  v_lshlrev_b32 v4, 16, v68
  v_and_b32 v5, 0xffff0000, v68
  v_pk_add_f32 v[124:125], v[124:125], v[4:5]
  v_lshlrev_b32 v4, 16, v69
  v_and_b32 v5, 0xffff0000, v69
  v_pk_add_f32 v[126:127], v[126:127], v[4:5]
  v_lshlrev_b32 v4, 16, v70
  v_and_b32 v5, 0xffff0000, v70
  v_pk_add_f32 v[128:129], v[128:129], v[4:5]
  v_lshlrev_b32 v4, 16, v71
  v_and_b32 v5, 0xffff0000, v71
  v_pk_add_f32 v[130:131], v[130:131], v[4:5]
  v_lshlrev_b32 v4, 16, v72
  v_and_b32 v5, 0xffff0000, v72
  v_pk_add_f32 v[132:133], v[132:133], v[4:5]
  v_lshlrev_b32 v4, 16, v73
  v_and_b32 v5, 0xffff0000, v73
  v_pk_add_f32 v[134:135], v[134:135], v[4:5]
  v_lshlrev_b32 v4, 16, v74
  v_and_b32 v5, 0xffff0000, v74
  v_pk_add_f32 v[136:137], v[136:137], v[4:5]
  v_lshlrev_b32 v4, 16, v75
  v_and_b32 v5, 0xffff0000, v75
  v_pk_add_f32 v[138:139], v[138:139], v[4:5]
  s_waitcnt vmcnt(0)
  v_lshlrev_b32 v4, 16, v76
  v_and_b32 v5, 0xffff0000, v76
  v_pk_add_f32 v[100:101], v[100:101], v[4:5]
  v_lshlrev_b32 v4, 16, v77
  v_and_b32 v5, 0xffff0000, v77
  v_pk_add_f32 v[102:103], v[102:103], v[4:5]
  v_lshlrev_b32 v4, 16, v78
  v_and_b32 v5, 0xffff0000, v78
  v_pk_add_f32 v[104:105], v[104:105], v[4:5]
  v_lshlrev_b32 v4, 16, v79
  v_and_b32 v5, 0xffff0000, v79
  v_pk_add_f32 v[106:107], v[106:107], v[4:5]
  v_lshlrev_b32 v4, 16, v80
  v_and_b32 v5, 0xffff0000, v80
  v_pk_add_f32 v[108:109], v[108:109], v[4:5]
  v_lshlrev_b32 v4, 16, v81
  v_and_b32 v5, 0xffff0000, v81
  v_pk_add_f32 v[110:111], v[110:111], v[4:5]
  v_lshlrev_b32 v4, 16, v82
  v_and_b32 v5, 0xffff0000, v82
  v_pk_add_f32 v[112:113], v[112:113], v[4:5]
  v_lshlrev_b32 v4, 16, v83
  v_and_b32 v5, 0xffff0000, v83
  v_pk_add_f32 v[114:115], v[114:115], v[4:5]
  v_lshlrev_b32 v4, 16, v84
  v_and_b32 v5, 0xffff0000, v84
  v_pk_add_f32 v[116:117], v[116:117], v[4:5]
  v_lshlrev_b32 v4, 16, v85
  v_and_b32 v5, 0xffff0000, v85
  v_pk_add_f32 v[118:119], v[118:119], v[4:5]
  v_lshlrev_b32 v4, 16, v86
  v_and_b32 v5, 0xffff0000, v86
  v_pk_add_f32 v[120:121], v[120:121], v[4:5]
  v_lshlrev_b32 v4, 16, v87
  v_and_b32 v5, 0xffff0000, v87
  v_pk_add_f32 v[122:123], v[122:123], v[4:5]
  v_lshlrev_b32 v4, 16, v88
  v_and_b32 v5, 0xffff0000, v88
  v_pk_add_f32 v[124:125], v[124:125], v[4:5]
  v_lshlrev_b32 v4, 16, v89
  v_and_b32 v5, 0xffff0000, v89
  v_pk_add_f32 v[126:127], v[126:127], v[4:5]
  v_lshlrev_b32 v4, 16, v90
  v_and_b32 v5, 0xffff0000, v90
  v_pk_add_f32 v[128:129], v[128:129], v[4:5]
  v_lshlrev_b32 v4, 16, v91
  v_and_b32 v5, 0xffff0000, v91
  v_pk_add_f32 v[130:131], v[130:131], v[4:5]
  v_lshlrev_b32 v4, 16, v92
  v_and_b32 v5, 0xffff0000, v92
  v_pk_add_f32 v[132:133], v[132:133], v[4:5]
  v_lshlrev_b32 v4, 16, v93
  v_and_b32 v5, 0xffff0000, v93
  v_pk_add_f32 v[134:135], v[134:135], v[4:5]
  v_lshlrev_b32 v4, 16, v94
  v_and_b32 v5, 0xffff0000, v94
  v_pk_add_f32 v[136:137], v[136:137], v[4:5]
  v_lshlrev_b32 v4, 16, v95
  v_and_b32 v5, 0xffff0000, v95
  v_pk_add_f32 v[138:139], v[138:139], v[4:5]
  s_mul_i32 s60, s26, 10240
  v_add_u32 v10, s60, v2
  ds_write_b128 v10, v[100:103] offset:0
  ds_write_b128 v10, v[104:107] offset:1024
  ds_write_b128 v10, v[108:111] offset:2048
  ds_write_b128 v10, v[112:115] offset:3072
  ds_write_b128 v10, v[116:119] offset:4096
  ds_write_b128 v10, v[120:123] offset:5120
  ds_write_b128 v10, v[124:127] offset:6144
  ds_write_b128 v10, v[128:131] offset:7168
  ds_write_b128 v10, v[132:135] offset:8192
  ds_write_b128 v10, v[136:139] offset:9216
  v_and_b32 v6, 15, v1
  v_lshlrev_b32 v6, 11, v6
  v_lshrrev_b32 v5, 4, v1
  v_lshlrev_b32 v5, 3, v5
  v_add_u32 v6, v6, v5
  s_mov_b32 s72, s26
  s_waitcnt lgkmcnt(0)
  s_barrier
concat_heads__gqa_block_cached__mha_block_cached__near_ridge_kernel_red:
  s_lshl_b32 s60, s72, 10
  v_add_u32 v10, s60, v2
  ds_read_b128 v[56:59], v10
  ds_read_b128 v[60:63], v10 offset:10240
  ds_read_b128 v[64:67], v10 offset:20480
  ds_read_b128 v[68:71], v10 offset:30720
  s_lshr_b32 s61, s72, 1
  s_lshl_b32 s61, s61, 15
  s_and_b32 s62, s72, 1
  s_lshl_b32 s62, s62, 5
  s_add_u32 s62, s62, s61
  s_waitcnt lgkmcnt(0)
  v_add_f32 v56, v56, v60
  v_add_f32 v64, v64, v68
  v_add_f32 v57, v57, v61
  v_add_f32 v65, v65, v69
  v_add_f32 v58, v58, v62
  v_add_f32 v66, v66, v70
  v_add_f32 v59, v59, v63
  v_add_f32 v67, v67, v71
  v_add_f32 v56, v56, v64
  v_add_f32 v57, v57, v65
  v_add_f32 v58, v58, v66
  v_add_f32 v59, v59, v67
  v_cvt_pk_bf16_f32 v72, v56, v57
  v_cvt_pk_bf16_f32 v73, v58, v59
  buffer_store_dwordx2 v[72:73], v6, s[48:51], s62 offen
  s_add_u32 s72, s72, 4
  s_cmp_lt_u32 s72, 10
  s_cbranch_scc1 concat_heads__gqa_block_cached__mha_block_cached__near_ridge_kernel_red
concat_heads__gqa_block_cached__mha_block_cached__near_ridge_kernel_end:
  s_endpgm
concat_heads__gqa_block_cached__mha_block_cached__near_ridge_kernel_fallback:
  s_waitcnt vmcnt(0) lgkmcnt(0)
  s_barrier
  v_lshrrev_b32 v22, 4, v1
  v_and_b32 v23, 15, v1
  s_mov_b32 s34, s17
  s_mov_b32 s38, s17
  s_mov_b32 s62, 0
  v_and_b32 v30, 3, v23
  v_lshlrev_b32 v30, 2, v30
  v_lshrrev_b32 v31, 2, v23
  v_or_b32 v30, v30, v31
  v_lshlrev_b32 v31, 2, v22
  v_xor_b32 v30, v30, v31
  v_lshlrev_b32 v28, 8, v23
  v_add_u32 v28, s52, v28
  v_xor_b32 v31, 0, v30
  v_lshlrev_b32 v31, 4, v31
  v_add_u32 v4, v28, v31
  v_xor_b32 v31, 1, v30
  v_lshlrev_b32 v31, 4, v31
  v_add_u32 v5, v28, v31
  v_xor_b32 v31, 2, v30
  v_lshlrev_b32 v31, 4, v31
  v_add_u32 v6, v28, v31
  v_xor_b32 v31, 3, v30
  v_lshlrev_b32 v31, 4, v31
  v_add_u32 v7, v28, v31
  v_mov_b32 v72, 0xff800000
  v_mov_b32 v73, 0xff800000
  v_mov_b32 v74, 0xff800000
  v_mov_b32 v75, 0xff800000
  v_mov_b32 v76, 0xff800000
concat_heads__gqa_block_cached__mha_block_cached__near_ridge_kernel_fbloop:
  s_mov_b32 m0, s52
  s_add_u32 s60, s62, 4096
  buffer_load_dwordx4 v16, s[32:35], s62 offen nt lds
  buffer_load_dwordx4 v17, s[32:35], s62 offen offset:1024 nt lds
  buffer_load_dwordx4 v18, s[32:35], s62 offen offset:2048 nt lds
  buffer_load_dwordx4 v19, s[32:35], s62 offen offset:3072 nt lds
  s_add_u32 m0, m0, 4096
  s_nop 0
  buffer_load_dwordx4 v16, s[32:35], s60 offen nt lds
  buffer_load_dwordx4 v17, s[32:35], s60 offen offset:1024 nt lds
  buffer_load_dwordx4 v18, s[32:35], s60 offen offset:2048 nt lds
  buffer_load_dwordx4 v19, s[32:35], s60 offen offset:3072 nt lds
  s_waitcnt vmcnt(0)
  ds_read_b128 v[132:135], v4
  ds_read_b128 v[136:139], v5
  ds_read_b128 v[140:143], v6
  ds_read_b128 v[144:147], v7
  ds_read_b128 v[148:151], v4 offset:4096
  ds_read_b128 v[152:155], v5 offset:4096
  ds_read_b128 v[156:159], v6 offset:4096
  ds_read_b128 v[160:163], v7 offset:4096
  s_waitcnt lgkmcnt(0)
  v_mfma_f32_16x16x32_bf16 v[32:35], v[132:135], a[160:163], 0
  v_mfma_f32_16x16x32_bf16 v[32:35], v[136:139], a[164:167], v[32:35]
  v_mfma_f32_16x16x32_bf16 v[32:35], v[140:143], a[168:171], v[32:35]
  v_mfma_f32_16x16x32_bf16 v[32:35], v[144:147], a[172:175], v[32:35]
  v_mfma_f32_16x16x32_bf16 v[36:39], v[148:151], a[160:163], 0
  v_mfma_f32_16x16x32_bf16 v[36:39], v[152:155], a[164:167], v[36:39]
  v_mfma_f32_16x16x32_bf16 v[36:39], v[156:159], a[168:171], v[36:39]
  v_mfma_f32_16x16x32_bf16 v[36:39], v[160:163], a[172:175], v[36:39]
  v_mfma_f32_16x16x32_bf16 v[40:43], v[132:135], a[176:179], 0
  v_mfma_f32_16x16x32_bf16 v[40:43], v[136:139], a[180:183], v[40:43]
  v_mfma_f32_16x16x32_bf16 v[40:43], v[140:143], a[184:187], v[40:43]
  v_mfma_f32_16x16x32_bf16 v[40:43], v[144:147], a[188:191], v[40:43]
  v_mfma_f32_16x16x32_bf16 v[44:47], v[148:151], a[176:179], 0
  v_mfma_f32_16x16x32_bf16 v[44:47], v[152:155], a[180:183], v[44:47]
  v_mfma_f32_16x16x32_bf16 v[44:47], v[156:159], a[184:187], v[44:47]
  v_mfma_f32_16x16x32_bf16 v[44:47], v[160:163], a[188:191], v[44:47]
  v_mfma_f32_16x16x32_bf16 v[48:51], v[132:135], a[192:195], 0
  v_mfma_f32_16x16x32_bf16 v[48:51], v[136:139], a[196:199], v[48:51]
  v_mfma_f32_16x16x32_bf16 v[48:51], v[140:143], a[200:203], v[48:51]
  v_mfma_f32_16x16x32_bf16 v[48:51], v[144:147], a[204:207], v[48:51]
  v_mfma_f32_16x16x32_bf16 v[52:55], v[148:151], a[192:195], 0
  v_mfma_f32_16x16x32_bf16 v[52:55], v[152:155], a[196:199], v[52:55]
  v_mfma_f32_16x16x32_bf16 v[52:55], v[156:159], a[200:203], v[52:55]
  v_mfma_f32_16x16x32_bf16 v[52:55], v[160:163], a[204:207], v[52:55]
  v_mfma_f32_16x16x32_bf16 v[56:59], v[132:135], a[208:211], 0
  v_mfma_f32_16x16x32_bf16 v[56:59], v[136:139], a[212:215], v[56:59]
  v_mfma_f32_16x16x32_bf16 v[56:59], v[140:143], a[216:219], v[56:59]
  v_mfma_f32_16x16x32_bf16 v[56:59], v[144:147], a[220:223], v[56:59]
  v_mfma_f32_16x16x32_bf16 v[60:63], v[148:151], a[208:211], 0
  v_mfma_f32_16x16x32_bf16 v[60:63], v[152:155], a[212:215], v[60:63]
  v_mfma_f32_16x16x32_bf16 v[60:63], v[156:159], a[216:219], v[60:63]
  v_mfma_f32_16x16x32_bf16 v[60:63], v[160:163], a[220:223], v[60:63]
  v_mfma_f32_16x16x32_bf16 v[64:67], v[132:135], a[224:227], 0
  v_mfma_f32_16x16x32_bf16 v[64:67], v[136:139], a[228:231], v[64:67]
  v_mfma_f32_16x16x32_bf16 v[64:67], v[140:143], a[232:235], v[64:67]
  v_mfma_f32_16x16x32_bf16 v[64:67], v[144:147], a[236:239], v[64:67]
  v_mfma_f32_16x16x32_bf16 v[68:71], v[148:151], a[224:227], 0
  v_mfma_f32_16x16x32_bf16 v[68:71], v[152:155], a[228:231], v[68:71]
  v_mfma_f32_16x16x32_bf16 v[68:71], v[156:159], a[232:235], v[68:71]
  v_mfma_f32_16x16x32_bf16 v[68:71], v[160:163], a[236:239], v[68:71]
  s_nop 7
  v_max3_f32 v72, v72, v32, v33
  v_max3_f32 v72, v72, v34, v35
  v_max3_f32 v72, v72, v36, v37
  v_max3_f32 v72, v72, v38, v39
  v_max3_f32 v73, v73, v40, v41
  v_max3_f32 v73, v73, v42, v43
  v_max3_f32 v73, v73, v44, v45
  v_max3_f32 v73, v73, v46, v47
  v_max3_f32 v74, v74, v48, v49
  v_max3_f32 v74, v74, v50, v51
  v_max3_f32 v74, v74, v52, v53
  v_max3_f32 v74, v74, v54, v55
  v_max3_f32 v75, v75, v56, v57
  v_max3_f32 v75, v75, v58, v59
  v_max3_f32 v75, v75, v60, v61
  v_max3_f32 v75, v75, v62, v63
  v_max3_f32 v76, v76, v64, v65
  v_max3_f32 v76, v76, v66, v67
  v_max3_f32 v76, v76, v68, v69
  v_max3_f32 v76, v76, v70, v71
  s_add_u32 s62, s62, 16384
  s_cmp_lt_u32 s62, 524288
  s_cbranch_scc1 concat_heads__gqa_block_cached__mha_block_cached__near_ridge_kernel_fbloop
  v_xor_b32 v24, 16, v1
  v_lshlrev_b32 v24, 2, v24
  v_xor_b32 v25, 32, v1
  v_lshlrev_b32 v25, 2, v25
  ds_bpermute_b32 v80, v24, v72
  ds_bpermute_b32 v81, v24, v73
  ds_bpermute_b32 v82, v24, v74
  ds_bpermute_b32 v83, v24, v75
  ds_bpermute_b32 v84, v24, v76
  s_waitcnt lgkmcnt(0)
  v_max_f32 v72, v72, v80
  v_max_f32 v73, v73, v81
  v_max_f32 v74, v74, v82
  v_max_f32 v75, v75, v83
  v_max_f32 v76, v76, v84
  ds_bpermute_b32 v80, v25, v72
  ds_bpermute_b32 v81, v25, v73
  ds_bpermute_b32 v82, v25, v74
  ds_bpermute_b32 v83, v25, v75
  ds_bpermute_b32 v84, v25, v76
  s_waitcnt lgkmcnt(0)
  v_max_f32 v72, v72, v80
  v_sub_f32 v92, 0, v72
  v_sub_f32 v93, 0, v72
  v_sub_f32 v94, 0, v72
  v_sub_f32 v95, 0, v72
  v_max_f32 v73, v73, v81
  v_sub_f32 v96, 0, v73
  v_sub_f32 v97, 0, v73
  v_sub_f32 v98, 0, v73
  v_sub_f32 v99, 0, v73
  v_max_f32 v74, v74, v82
  v_sub_f32 v100, 0, v74
  v_sub_f32 v101, 0, v74
  v_sub_f32 v102, 0, v74
  v_sub_f32 v103, 0, v74
  v_max_f32 v75, v75, v83
  v_sub_f32 v104, 0, v75
  v_sub_f32 v105, 0, v75
  v_sub_f32 v106, 0, v75
  v_sub_f32 v107, 0, v75
  v_max_f32 v76, v76, v84
  v_sub_f32 v108, 0, v76
  v_sub_f32 v109, 0, v76
  v_sub_f32 v110, 0, v76
  v_sub_f32 v111, 0, v76
  v_and_b32 v30, 3, v23
  v_lshlrev_b32 v30, 2, v30
  v_lshrrev_b32 v31, 2, v23
  v_or_b32 v30, v30, v31
  v_lshlrev_b32 v31, 2, v22
  v_xor_b32 v30, v30, v31
  v_lshlrev_b32 v28, 8, v23
  v_add_u32 v28, s64, v28
  v_xor_b32 v31, 0, v30
  v_lshlrev_b32 v31, 4, v31
  v_add_u32 v4, v28, v31
  v_xor_b32 v31, 1, v30
  v_lshlrev_b32 v31, 4, v31
  v_add_u32 v5, v28, v31
  v_xor_b32 v31, 2, v30
  v_lshlrev_b32 v31, 4, v31
  v_add_u32 v6, v28, v31
  v_xor_b32 v31, 3, v30
  v_lshlrev_b32 v31, 4, v31
  v_add_u32 v7, v28, v31
  v_lshrrev_b32 v30, 2, v23
  v_lshlrev_b32 v31, 2, v22
  v_add_u32 v30, v30, v31
  v_and_b32 v31, 7, v30
  v_lshlrev_b32 v31, 1, v31
  v_bfe_u32 v28, v23, 1, 1
  v_xor_b32 v31, v31, v28
  s_lshl_b32 s59, s27, 3
  v_xor_b32 v31, s59, v31
  v_lshlrev_b32 v30, 8, v30
  v_and_b32 v28, 1, v23
  v_lshlrev_b32 v28, 3, v28
  v_add_u32 v30, v30, v28
  s_add_u32 s60, s64, 8192
  v_add_u32 v30, s60, v30
  v_xor_b32 v28, 0, v31
  v_lshlrev_b32 v28, 4, v28
  v_add_u32 v8, v30, v28
  v_xor_b32 v28, 2, v31
  v_lshlrev_b32 v28, 4, v28
  v_add_u32 v9, v30, v28
  v_xor_b32 v28, 4, v31
  v_lshlrev_b32 v28, 4, v28
  v_add_u32 v10, v30, v28
  v_xor_b32 v28, 6, v31
  v_lshlrev_b32 v28, 4, v28
  v_add_u32 v11, v30, v28
  v_xor_b32 v28, 8, v31
  v_lshlrev_b32 v28, 4, v28
  v_add_u32 v12, v30, v28
  v_xor_b32 v28, 10, v31
  v_lshlrev_b32 v28, 4, v28
  v_add_u32 v13, v30, v28
  v_xor_b32 v28, 12, v31
  v_lshlrev_b32 v28, 4, v28
  v_add_u32 v14, v30, v28
  v_xor_b32 v28, 14, v31
  v_lshlrev_b32 v28, 4, v28
  v_add_u32 v15, v30, v28
  s_mov_b32 s16, 1
  s_waitcnt vmcnt(0) lgkmcnt(0)
  s_barrier
  s_branch concat_heads__gqa_block_cached__mha_block_cached__near_ridge_kernel_restart
.section .rodata,"a"
.p2align 6
.amdhsa_kernel concat_heads__gqa_block_cached__mha_block_cached__near_ridge_kernel
  .amdhsa_next_free_vgpr 512
  .amdhsa_next_free_sgpr 100
  .amdhsa_accum_offset 256
  .amdhsa_group_segment_fixed_size 0
  .amdhsa_kernarg_size 104
  .amdhsa_user_sgpr_count 2
  .amdhsa_user_sgpr_kernarg_segment_ptr 1
  .amdhsa_system_sgpr_workgroup_id_x 1
  .amdhsa_float_denorm_mode_32 3
.end_amdhsa_kernel
```
